```python
import torch

def _softmax(x, axis=-1):
    return torch.softmax(x, dim=axis)

def _gelu(x):
    return torch.nn.functional.gelu(x, approximate='tanh')

def _silu(x):
    return torch.nn.functional.silu(x)

def _sigmoid(x):
    return torch.sigmoid(x)

def _layernorm(x, axis=-1, eps=1e-05):
    m = x.mean(dim=axis, keepdim=True)
    v = x.var(dim=axis, keepdim=True, unbiased=False)
    return (x - m) / torch.sqrt(v + eps)

def _scatter_add(tgt, idx, src, axis=0):
    return tgt.clone().index_add_(axis, idx, src)

def _segment_sum(src, seg, n):
    out = torch.zeros((n,) + src.shape[1:], dtype=src.dtype)
    return out.index_add_(0, seg, src)

def _pad(x, pw):
    flat = tuple((v for pair in reversed(pw) for v in pair))
    return torch.nn.functional.pad(x, flat)
kernel_name = 'adaLN_cond__sliding_block_cached__glu_gated_glu__decode'

def setup_inputs():

    _w = lambda a: (lambda t: t.to(torch.bfloat16) if t.is_floating_point() else t)(torch.as_tensor(a))

    def _A_setup():
        B, Sq, D = (1, 1, 512)
        Hq, Hkv, Sk, Dh = (32, 8, 16384, 128)
        assert Hq % Hkv == 0, (Hq, Hkv)
        return {'x': _w((lambda *s: torch.randn(*s, dtype=torch.bfloat16) * 0.1)(B, Sq, D)), 'k_cache': _w((lambda *s: torch.randn(*s, dtype=torch.bfloat16) * 0.8)(B, Hkv, Sk, Dh)), 'v_cache': _w((lambda *s: torch.randn(*s, dtype=torch.bfloat16) * 0.8)(B, Hkv, Sk, Dh)), 'wq': _w((lambda *s: torch.randn(*s, dtype=torch.bfloat16) * 0.8)(D, Hq * Dh) * D ** (-0.5)), 'wo': _w((lambda *s: torch.randn(*s, dtype=torch.bfloat16) * 0.8)(Hq * Dh, D) * (Hq * Dh) ** (-0.5))}
    _A_in = _A_setup()

    def _B_setup():
        B, S, D, F = (1, 1, 512, 1792)
        return {'x': _w((lambda *s: torch.randn(*s, dtype=torch.bfloat16) * 0.1)(B, S, D)), 'w_gate': _w((lambda *s: torch.randn(*s, dtype=torch.bfloat16) * 0.2)(D, F)), 'w_up': _w((lambda *s: torch.randn(*s, dtype=torch.bfloat16) * 0.1)(D, F)), 'w_down': _w((lambda *s: torch.randn(*s, dtype=torch.bfloat16) * 0.1)(F, D))}
    _B_in = _B_setup()
    return {'A_x': _A_in['x'], 'A_k_cache': _A_in['k_cache'], 'A_v_cache': _A_in['v_cache'], 'A_wq': _A_in['wq'], 'A_wo': _A_in['wo'], 'B_x': _B_in['x'], 'B_w_gate': _B_in['w_gate'], 'B_w_up': _B_in['w_up'], 'B_w_down': _B_in['w_down'], 'c': _w((lambda *s: torch.randn(*s, dtype=torch.bfloat16) * 0.4)(1, 512) * 8.0), 'w_mod': _w((lambda *s: torch.randn(*s, dtype=torch.bfloat16) * 0.4)(512, 6 * 512) * 512 ** (-0.5) * 8.0)}

def reference(A_x, A_k_cache, A_v_cache, A_wq, A_wo, B_x, B_w_gate, B_w_up, B_w_down, c, w_mod):

    def _A_ref(x, k_cache, v_cache, wq, wo):
        B, Sq, D = x.shape
        Hq, Dh = (32, 128)
        Hkv, Sk = (k_cache.shape[1], k_cache.shape[2])
        W = min(4096, max(256, Sk // 4))
        rep = Hq // Hkv
        q = (lambda x, *d: x.permute(*d))((x @ wq).reshape(B, Sq, Hq, Dh), 0, 2, 1, 3)
        k = (lambda x, n, axis: torch.repeat_interleave(x, n, dim=axis))(k_cache[:, :, Sk - W:, :], rep, axis=1)
        v = (lambda x, n, axis: torch.repeat_interleave(x, n, dim=axis))(v_cache[:, :, Sk - W:, :], rep, axis=1)
        scores = torch.einsum('bhqd,bhkd->bhqk', q, k) * Dh ** (-0.5)
        p = _softmax(scores, axis=-1)
        o = torch.einsum('bhqk,bhkd->bhqd', p, v)
        return (lambda x, *d: x.permute(*d))(o, 0, 2, 1, 3).reshape(B, Sq, Hq * Dh) @ wo

    def _B_ref(x, w_gate, w_up, w_down):
        g = torch.einsum('bsd,df->bsf', x, w_gate)
        u = torch.einsum('bsd,df->bsf', x, w_up)
        h = _sigmoid(g) * u
        return torch.einsum('bsf,fd->bsd', h, w_down)
    x = A_x
    mod = (_silu(c) @ w_mod).reshape(c.shape[0], 6, 1, -1)
    sa, ca, ga, sb, cb, gb = (mod[:, 0].clone(), mod[:, 1].clone(), mod[:, 2].clone(), mod[:, 3].clone(), mod[:, 4].clone(), mod[:, 5].clone())
    h = _layernorm(x, axis=-1) * (1 + ca) + sa
    x = x + ga * _A_ref(h, A_k_cache, A_v_cache, A_wq, A_wo)
    h = _layernorm(x, axis=-1) * (1 + cb) + sb
    x = x + gb * _B_ref(h, B_w_gate, B_w_up, B_w_down)
    return x
```

```asm
; @launch grid=(256,1,1) block=(640,1,1) lds=161280
.amdgcn_target "amdgcn-amd-amdhsa--gfx950"
.text
.globl adaLN_cond__sliding_block_cached__glu_gated_glu__decode_kernel
.p2align 8
.type adaLN_cond__sliding_block_cached__glu_gated_glu__decode_kernel,@function
adaLN_cond__sliding_block_cached__glu_gated_glu__decode_kernel:
L_start:
    s_cmp_ge_u32 s2, 256
    s_cbranch_scc1 L_exit
    s_load_dwordx16 s[16:31], s[0:1], 0
    s_load_dwordx8 s[32:39], s[0:1], 64
    s_load_dwordx4 s[40:43], s[0:1], 96
    v_lshrrev_b32 v1, 6, v0
    v_and_b32 v0, 63, v0
    v_readfirstlane_b32 s3, v1
    s_and_b32 s4, s2, 7
    s_lshr_b32 s5, s2, 3
    s_and_b32 s10, s5, 15
    s_cmp_lt_u32 s3, 8
    s_cbranch_scc1 L_i_c
    s_cmp_eq_u32 s3, 9
    s_cbranch_scc0 L_i_8
    s_getpc_b64 s[56:57]
L_pc:
    s_sub_u32 s56, s56, L_pc - L_start
    s_subb_u32 s57, s57, 0
    s_and_b32 s58, s5, 3
    s_lshl_b32 s58, s58, 13
    v_lshl_add_u32 v5, v0, 7, s58
    v_min_u32 v5, L_codeend - L_start - 4, v5
    global_load_dword v17, v5, s[56:57]
    s_branch L_i_9
L_i_8:
    s_setprio 3
    v_lshrrev_b32 v2, 3, v0
    v_and_b32 v3, 7, v0
    s_lshl_b32 s58, s4, 7
    s_cmp_ge_u32 s5, 16
    s_cbranch_scc1 L_i_8W
    v_mul_u32_u24 v1, 6144, v2
    s_lshr_b32 s56, s10, 1
    s_mul_i32 s56, s56, 393216
    s_and_b32 s57, s10, 1
    s_lshl_b32 s57, s57, 10
    s_add_u32 s56, s56, s57
    s_add_u32 s56, s56, s58
    s_mov_b32 m0, 131072
    s_mov_b32 s59, 49152
    s_mov_b32 s60, 1
    s_waitcnt lgkmcnt(0)
    s_mov_b64 s[62:63], s[36:37]
    s_branch L_i_8go
L_i_8W:
    v_lshlrev_b32 v1, 13, v2
    s_lshr_b32 s56, s10, 3
    s_lshl_b32 s56, s56, 21
    s_and_b32 s57, s10, 7
    s_lshl_b32 s57, s57, 7
    s_add_u32 s56, s56, s57
    s_lshl_b32 s58, s58, 3
    s_add_u32 s56, s56, s58
    s_mov_b32 m0, 0
    s_mov_b32 s59, 65536
    s_mov_b32 s60, 4
    s_waitcnt lgkmcnt(0)
    s_mov_b64 s[62:63], s[22:23]
L_i_8go:
    v_lshl_add_u32 v1, v3, 4, v1
    v_add_u32 v1, s56, v1
L_i_8loop:
    global_load_lds_dwordx4 v1, s[62:63] nt
    s_add_u32 m0, m0, 1024
    v_add_u32 v1, s59, v1
    global_load_lds_dwordx4 v1, s[62:63] nt
    s_add_u32 m0, m0, 1024
    v_add_u32 v1, s59, v1
    global_load_lds_dwordx4 v1, s[62:63] nt
    s_add_u32 m0, m0, 1024
    v_add_u32 v1, s59, v1
    global_load_lds_dwordx4 v1, s[62:63] nt
    s_add_u32 m0, m0, 1024
    v_add_u32 v1, s59, v1
    global_load_lds_dwordx4 v1, s[62:63] nt
    s_add_u32 m0, m0, 1024
    v_add_u32 v1, s59, v1
    global_load_lds_dwordx4 v1, s[62:63] nt
    s_add_u32 m0, m0, 1024
    v_add_u32 v1, s59, v1
    global_load_lds_dwordx4 v1, s[62:63] nt
    s_add_u32 m0, m0, 1024
    v_add_u32 v1, s59, v1
    global_load_lds_dwordx4 v1, s[62:63] nt
    s_add_u32 m0, m0, 1024
    v_add_u32 v1, s59, v1
    s_sub_u32 s60, s60, 1
    s_cmp_lg_u32 s60, 0
    s_cbranch_scc1 L_i_8loop
    s_branch L_loader
L_i_c:
    s_cmp_ge_u32 s3, 4
    s_cbranch_scc0 L_i_03
    s_lshr_b32 s56, s10, 2
    s_lshl_b32 s56, s56, 8
    v_lshl_add_u32 v7, v0, 2, s56
    s_waitcnt lgkmcnt(0)
    global_load_dword v24, v7, s[34:35]
    s_branch L_i_done
L_i_03:
    v_lshlrev_b32 v5, 4, v0
    s_add_u32 s57, s3, 1
    s_and_b32 s57, s57, 1
    s_lshl_b32 s56, s10, 1
    s_add_u32 s56, s56, s57
    s_lshl_b32 s56, s56, 5
    v_and_b32 v6, 15, v0
    v_lshl_add_u32 v6, v6, 1, s56
    s_sub_u32 s57, s3, 1
    s_lshr_b32 s56, s5, 4
    s_xor_b32 s56, s56, 1
    s_lshl_b32 s56, s56, 1
    s_or_b32 s57, s57, s56
    s_waitcnt lgkmcnt(0)
    s_cmp_lt_u32 s57, 2
    s_cbranch_scc0 L_i_done
    global_load_dwordx4 v[20:23], v5, s[16:17]
    global_load_ushort v24, v6, s[16:17]
    s_branch L_i_done
L_i_9:
    s_setprio 3
    v_lshlrev_b32 v6, 2, v0
    v_add_u32 v6, 160000, v6
    v_mov_b32 v7, 0
    s_mov_b32 exec_lo, 0xffffffff
    s_mov_b32 exec_hi, 0x0
    ds_write_b32 v6, v7
    s_mov_b64 exec, -1
    s_getreg_b32 s52, hwreg(HW_REG_XCC_ID)
    s_and_b32 s52, s52, 15
    s_or_b32 s52, s52, 0x80
    s_lshl_b32 s56, s4, 5
    s_add_u32 s57, s56, s5
    v_mov_b32 v5, s57
    v_mov_b32 v6, s52
    s_waitcnt lgkmcnt(0)
    s_mov_b64 exec, 1
    global_store_byte v5, v6, s[40:41]
    s_mov_b64 exec, -1
L_i_done:
    s_load_dword s6, s[42:43], 0
    s_getreg_b32 s51, hwreg(HW_REG_XCC_ID)
    s_and_b32 s51, s51, 4
    s_lshl_b32 s51, s51, 11
    s_mov_b32 s47, 0xffffffc0
    s_mov_b32 s48, 0x07060302
    s_mov_b32 s49, 0xffff0000
    s_mov_b32 s50, 0x3fb8aa3b
    s_mov_b32 s46, 0
    s_mul_i32 s53, s4, 98304
    s_add_u32 s53, s53, 262144
    s_add_u32 s44, s42, s53
    s_addc_u32 s45, s43, 0
    v_mov_b32 v10, 160000
    v_mov_b32 v14, 1
    v_mov_b32 v18, 0
    v_and_b32 v1, 15, v0
    v_lshrrev_b32 v2, 4, v0
    v_bfe_u32 v3, v0, 2, 2
    v_and_b32 v4, 3, v0
    v_lshlrev_b32 v15, 3, v4
    v_lshlrev_b32 v16, 4, v2
    s_lshl_b32 s59, s3, 2
    s_lshl_b32 s60, s3, 5
    s_lshl_b32 s61, s3, 6
    s_lshl_b32 s62, s3, 7
    s_lshl_b32 s63, s3, 8
    s_cmp_ge_u32 s5, 16
    s_cbranch_scc1 L_W
    s_cmp_eq_u32 s3, 9
    s_cbranch_scc1 L_A9
    s_lshl_b32 s58, s3, 13
    v_xor_b32 v5, v2, v1
    v_lshlrev_b32 v5, 4, v5
    v_lshl_add_u32 v5, v1, 8, v5
    v_add_u32 v25, s58, v5
    v_xor_b32 v26, 64, v25
    v_xor_b32 v27, 128, v25
    v_xor_b32 v28, 192, v25
    v_mul_u32_u24 v29, 320, v4
    v_add3_u32 v29, v29, v16, v10
    v_add_u32 v29, -2304, v29
    v_lshlrev_b32 v31, 5, v4
    v_add_u32 v31, 159232, v31
    v_add_u32 v30, s59, v31
    v_lshl_add_u32 v5, v2, 2, v3
    v_and_b32 v6, 7, v5
    v_lshl_add_u32 v32, v5, 8, v15
    v_lshl_add_u32 v32, v6, 5, v32
    v_xor_b32 v32, s60, v32
    v_add_u32 v32, 65536, v32
    v_lshl_add_u32 v7, v4, 6, v16
    s_add_u32 s56, s63, 139264
    v_lshl_add_u32 v33, v3, 2, v7
    v_add_u32 v33, s56, v33
    v_add_u32 v34, 139264, v7
    s_lshl_b32 s57, s10, 11
    s_add_u32 s56, s57, s61
    s_add_u32 s56, s56, 32768
    v_lshl_add_u32 v35, v4, 9, v16
    v_add_u32 v35, s56, v35
    s_barrier
    s_waitcnt lgkmcnt(0)
    s_add_u32 s6, s6, 1
    s_and_b32 s7, s6, 0x3f
    s_and_b32 s8, s6, 0xffff
    s_xor_b32 s9, s7, 0x20
    v_mov_b32 v11, s7
    v_mov_b32 v12, s9
    s_cmp_ge_u32 s3, 4
    s_cbranch_scc0 L_A_main
    s_lshl_b32 s56, s10, 3
    s_add_u32 s56, s56, s4
    s_lshl_b32 s56, s56, 8
    s_add_u32 s56, s56, s61
    s_sub_u32 s56, s56, 256
    s_and_b32 s57, s56, 0xffffe000
    s_add_u32 s56, s56, s57
    s_add_u32 s56, s56, 65536
    v_lshl_add_u32 v36, v1, 13, v16
    v_add_u32 v36, s56, v36
    s_sub_u32 s56, s63, -159232
    v_lshl_add_u32 v7, v0, 2, s56
    s_and_b32 s57, s10, 2
    s_lshl_b32 s57, s57, 6
    s_add_u32 s56, s56, s57
    v_add_u32 v61, s56, v16
    s_sub_u32 s56, s60, -130944
    v_lshl_add_u32 v60, v2, 3, v3
    v_lshl_add_u32 v60, v60, 7, v15
    v_add_u32 v60, s56, v60
    s_waitcnt vmcnt(0)
    v_lshlrev_b32 v20, 16, v24
    v_and_b32 v21, s49, v24
    v_mul_f32 v5, s50, v20
    v_exp_f32 v5, -v5
    s_nop 0
    v_add_f32 v5, 1.0, v5
    v_rcp_f32 v22, v5
    s_nop 0
    v_mul_f32 v23, v20, v22
    v_fma_f32 v5, -v23, v5, v20
    v_fma_f32 v5, v5, v22, v23
    v_cmp_o_f32 vcc, v5, v5
    s_nop 1
    v_cndmask_b32 v20, v23, v5, vcc
    v_mul_f32 v6, s50, v21
    v_exp_f32 v6, -v6
    s_nop 0
    v_add_f32 v6, 1.0, v6
    v_rcp_f32 v22, v6
    s_nop 0
    v_mul_f32 v23, v21, v22
    v_fma_f32 v6, -v23, v6, v21
    v_fma_f32 v6, v6, v22, v23
    v_cmp_o_f32 vcc, v6, v6
    s_nop 1
    v_cndmask_b32 v21, v23, v6, vcc
    v_cvt_pk_bf16_f32 v24, v20, v21
    ds_write_b32 v7, v24
    ds_read_b128 v[40:43], v61 offset:0
    ds_read_b128 v[44:47], v61 offset:64
    ds_read_b32 v5, v10 offset:0
    ds_read_b64_tr_b16 v[48:49], v60 offset:0
    ds_read_b64_tr_b16 v[50:51], v60 offset:512
    ds_read_b64_tr_b16 v[52:53], v60 offset:4096
    ds_read_b64_tr_b16 v[54:55], v60 offset:4608
    s_waitcnt lgkmcnt(4)
    v_readfirstlane_b32 s15, v5
    s_cmp_ge_u32 s15, 1
    s_cbranch_scc1 OK_2
    s_mov_b32 s14, 2000000
W_1:
    ds_read_b32 v5, v10 offset:0
    s_waitcnt lgkmcnt(0)
    v_readfirstlane_b32 s15, v5
    s_cmp_ge_u32 s15, 1
    s_cbranch_scc1 AG_3
    s_sub_u32 s14, s14, 1
    s_cbranch_scc0 W_1
    s_branch L_fail
AG_3:
    ds_read_b64_tr_b16 v[48:49], v60 offset:0
    ds_read_b64_tr_b16 v[50:51], v60 offset:512
    ds_read_b64_tr_b16 v[52:53], v60 offset:4096
    ds_read_b64_tr_b16 v[54:55], v60 offset:4608
OK_2:
    s_waitcnt lgkmcnt(2)
    v_mfma_f32_16x16x32_bf16 v[56:59], v[48:51], v[40:43], 0
    s_waitcnt lgkmcnt(0)
    v_mfma_f32_16x16x32_bf16 v[56:59], v[52:55], v[44:47], v[56:59]
    s_nop 7
    v_and_or_b32 v56, v56, s47, v11
    v_and_or_b32 v57, v57, s47, v11
    v_and_or_b32 v58, v58, s47, v11
    v_and_or_b32 v59, v59, s47, v11
    s_mov_b32 exec_lo, 0x30003
    s_mov_b32 exec_hi, 0x30003
    global_store_dwordx4 v36, v[56:59], s[42:43] sc1
    s_mov_b64 exec, 1
    ds_add_u32 v10, v14 offset:44
    s_mov_b64 exec, -1
L_A_main:
    s_add_u32 s57, s3, 2
    s_mov_b32 s14, 2000000
W_4:
    ds_read_b32 v5, v10 offset:0
    s_waitcnt lgkmcnt(0)
    v_readfirstlane_b32 s15, v5
    s_cmp_ge_u32 s15, s57
    s_cbranch_scc1 AG_6
    s_sleep 1
    s_sub_u32 s14, s14, 1
    s_cbranch_scc0 W_4
    s_branch L_fail
AG_6:
OK_5:
    ds_read_b128 v[36:39], v25 offset:0
    ds_read_b128 v[40:43], v26 offset:0
    ds_read_b128 v[44:47], v27 offset:0
    ds_read_b128 v[48:51], v28 offset:0
    ds_read_b128 v[52:55], v25 offset:4096
    ds_read_b128 v[56:59], v26 offset:4096
    ds_read_b128 v[60:63], v27 offset:4096
    ds_read_b128 v[64:67], v28 offset:4096
    s_mov_b32 s13, 0
    s_mov_b32 s58, 14
    s_mov_b32 s14, 2000000
W_7:
    ds_read_b32 v6, v10 offset:56
    ds_read_b32 v7, v10 offset:0
    s_waitcnt lgkmcnt(0)
    v_readfirstlane_b32 s15, v6
    v_readfirstlane_b32 s56, v7
    s_cmp_eq_u32 s15, 1
    s_cbranch_scc1 OK_8
    s_cmp_ge_u32 s56, s58
    s_cbranch_scc0 NV_9
    s_cmp_eq_u32 s13, 0
    s_cbranch_scc0 N2_10
    ds_read_b64_tr_b16 v[68:69], v32 offset:0
    ds_read_b64_tr_b16 v[70:71], v32 offset:4096
    ds_read_b64_tr_b16 v[72:73], v32 offset:8192
    ds_read_b64_tr_b16 v[74:75], v32 offset:12288
    ds_read_b64_tr_b16 v[76:77], v32 offset:16384
    ds_read_b64_tr_b16 v[78:79], v32 offset:20480
    ds_read_b64_tr_b16 v[80:81], v32 offset:24576
    ds_read_b64_tr_b16 v[82:83], v32 offset:28672
    ds_read_b64_tr_b16 v[84:85], v32 offset:32768
    ds_read_b64_tr_b16 v[86:87], v32 offset:36864
    s_mov_b32 s13, 1
    s_mov_b32 s58, 17
    s_branch NV_9
N2_10:
    ds_read_b64_tr_b16 v[88:89], v32 offset:40960
    ds_read_b64_tr_b16 v[90:91], v32 offset:45056
    ds_read_b64_tr_b16 v[92:93], v32 offset:49152
    ds_read_b64_tr_b16 v[94:95], v32 offset:53248
    ds_read_b64_tr_b16 v[96:97], v32 offset:57344
    ds_read_b64_tr_b16 v[98:99], v32 offset:61440
    s_mov_b32 s13, 2
    s_mov_b32 s58, 99
NV_9:
    s_sub_u32 s14, s14, 1
    s_cbranch_scc0 W_7
    s_branch L_fail
OK_8:
    ds_read_b128 v[100:103], v29 offset:0
    ds_read_b128 v[104:107], v29 offset:64
    ds_read_b128 v[108:111], v29 offset:128
    ds_read_b128 v[112:115], v29 offset:192
    ds_read_b32 v13, v10 offset:52
    s_waitcnt lgkmcnt(4)
    v_mfma_f32_16x16x32_bf16 v[116:119], v[36:39], v[100:103], 0
    v_mfma_f32_16x16x32_bf16 v[120:123], v[52:55], v[100:103], 0
    s_waitcnt lgkmcnt(3)
    v_mfma_f32_16x16x32_bf16 v[116:119], v[40:43], v[104:107], v[116:119]
    v_mfma_f32_16x16x32_bf16 v[120:123], v[56:59], v[104:107], v[120:123]
    s_waitcnt lgkmcnt(2)
    v_mfma_f32_16x16x32_bf16 v[116:119], v[44:47], v[108:111], v[116:119]
    v_mfma_f32_16x16x32_bf16 v[120:123], v[60:63], v[108:111], v[120:123]
    s_waitcnt lgkmcnt(1)
    v_mfma_f32_16x16x32_bf16 v[116:119], v[48:51], v[112:115], v[116:119]
    v_mfma_f32_16x16x32_bf16 v[120:123], v[64:67], v[112:115], v[120:123]
    s_waitcnt lgkmcnt(0)
    v_readfirstlane_b32 s46, v13
    s_mov_b32 s56, 0x3db504f3
    s_nop 3
    v_mov_b32_dpp v116, v118 quad_perm:[0,1,2,3] row_mask:0xf bank_mask:0x2
    v_mov_b32_dpp v117, v119 quad_perm:[0,1,2,3] row_mask:0xf bank_mask:0x2
    s_nop 0
    v_mov_b32_dpp v116, v120 quad_perm:[0,1,2,3] row_mask:0xf bank_mask:0x4
    v_mov_b32_dpp v117, v121 quad_perm:[0,1,2,3] row_mask:0xf bank_mask:0x4
    s_nop 0
    v_mov_b32_dpp v116, v122 quad_perm:[0,1,2,3] row_mask:0xf bank_mask:0x8
    v_mov_b32_dpp v117, v123 quad_perm:[0,1,2,3] row_mask:0xf bank_mask:0x8
    v_cvt_pk_bf16_f32 v124, v116, v117
    v_lshlrev_b32 v116, 16, v124
    v_and_b32 v117, s49, v124
    v_mul_f32 v116, s56, v116
    v_mul_f32 v117, s56, v117
    v_cvt_pk_bf16_f32 v124, v116, v117
    v_lshlrev_b32 v116, 16, v124
    v_and_b32 v117, s49, v124
    v_max_f32 v125, v116, v117
    s_nop 1
    v_max_f32_dpp v125, v125, v125 row_ror:4 row_mask:0xf bank_mask:0xf
    s_nop 1
    v_max_f32_dpp v125, v125, v125 row_ror:8 row_mask:0xf bank_mask:0xf
    v_mov_b32 v5, v125
    s_nop 1
    v_permlane16_swap_b32 v125, v5
    v_max_f32 v125, v125, v5
    v_mov_b32 v5, v125
    s_nop 1
    v_permlane32_swap_b32 v125, v5
    v_max_f32 v125, v125, v5
    s_mov_b64 exec, 15
    ds_write_b32 v30, v125
    s_mov_b64 exec, 1
    ds_add_u32 v10, v14 offset:60
    s_mov_b64 exec, -1
    s_mov_b32 s14, 2000000
W_11:
    ds_read_b32 v6, v10 offset:60
    ds_read_b128 v[100:103], v31
    ds_read_b128 v[104:107], v31 offset:16
    s_waitcnt lgkmcnt(2)
    v_cmp_ne_u32 vcc, 8, v6
    s_cbranch_vccz OK_12
    s_sub_u32 s14, s14, 1
    s_cbranch_scc0 W_11
    s_branch L_fail
OK_12:
    s_waitcnt lgkmcnt(0)
    v_max3_f32 v125, v100, v101, v102
    v_max3_f32 v5, v103, v104, v105
    v_max3_f32 v125, v125, v106, v107
    v_max_f32 v125, v125, v5
    v_mul_f32 v6, s50, v125
    v_fma_f32 v116, v116, s50, -v6
    v_fma_f32 v117, v117, s50, -v6
    v_exp_f32 v116, v116
    v_exp_f32 v117, v117
    s_nop 0
    v_cvt_pk_bf16_f32 v124, v116, v117
    ds_write_b32 v33, v124
    s_mov_b64 exec, 1
    ds_add_u32 v10, v14 offset:4
    s_mov_b64 exec, -1
    v_add_f32 v126, v116, v117
    s_nop 1
    v_add_f32_dpp v126, v126, v126 row_ror:4 row_mask:0xf bank_mask:0xf
    s_nop 1
    v_add_f32_dpp v126, v126, v126 row_ror:8 row_mask:0xf bank_mask:0xf
    v_mov_b32 v8, v126
    s_nop 1
    v_permlane16_swap_b32 v126, v8
    v_add_f32 v126, v126, v8
    v_mov_b32 v8, v126
    s_nop 1
    v_permlane32_swap_b32 v126, v8
    v_add_f32 v126, v126, v8
    s_mov_b64 exec, 15
    ds_write_b32 v30, v126 offset:128
    s_mov_b64 exec, 1
    ds_add_u32 v10, v14 offset:48
    s_mov_b64 exec, -1
    s_mov_b32 s14, 2000000
W_13:
    ds_read_b64 v[108:109], v10
    s_waitcnt lgkmcnt(0)
    v_cmp_ne_u32 vcc, 8, v109
    s_cbranch_vccz OK_14
    s_sub_u32 s14, s14, 1
    s_cbranch_scc0 W_13
    s_branch L_fail
OK_14:
    ds_read_b128 v[36:39], v34 offset:0
    ds_read_b128 v[40:43], v34 offset:256
    ds_read_b128 v[44:47], v34 offset:512
    ds_read_b128 v[48:51], v34 offset:768
    ds_read_b128 v[52:55], v34 offset:1024
    ds_read_b128 v[56:59], v34 offset:1280
    ds_read_b128 v[60:63], v34 offset:1536
    ds_read_b128 v[64:67], v34 offset:1792
    s_cmp_eq_u32 s13, 2
    s_cbranch_scc0 L_A_vlate
    s_waitcnt lgkmcnt(7)
    v_mfma_f32_16x16x32_bf16 v[112:115], v[68:71], v[36:39], 0
    s_waitcnt lgkmcnt(6)
    v_mfma_f32_16x16x32_bf16 v[112:115], v[72:75], v[40:43], v[112:115]
    s_waitcnt lgkmcnt(5)
    v_mfma_f32_16x16x32_bf16 v[112:115], v[76:79], v[44:47], v[112:115]
    s_waitcnt lgkmcnt(4)
    v_mfma_f32_16x16x32_bf16 v[112:115], v[80:83], v[48:51], v[112:115]
    s_waitcnt lgkmcnt(3)
    v_mfma_f32_16x16x32_bf16 v[112:115], v[84:87], v[52:55], v[112:115]
    s_waitcnt lgkmcnt(2)
    v_mfma_f32_16x16x32_bf16 v[112:115], v[88:91], v[56:59], v[112:115]
    s_waitcnt lgkmcnt(1)
    v_mfma_f32_16x16x32_bf16 v[112:115], v[92:95], v[60:63], v[112:115]
    s_waitcnt lgkmcnt(0)
    v_mfma_f32_16x16x32_bf16 v[112:115], v[96:99], v[64:67], v[112:115]
L_A_pvdone:
    s_nop 7
    v_and_or_b32 v112, v112, s47, v11
    v_and_or_b32 v113, v113, s47, v11
    v_and_or_b32 v114, v114, s47, v11
    v_and_or_b32 v115, v115, s47, v11
    s_mov_b32 exec_lo, 0xf000f
    s_mov_b32 exec_hi, 0xf000f
    s_cmp_eq_u32 s46, 1
    s_cbranch_scc0 SL_15
    global_store_dwordx4 v35, v[112:115], s[44:45]
BK_16:
    s_mov_b64 exec, 1
    ds_add_u32 v10, v14 offset:16
    s_mov_b64 exec, -1
    s_cmp_ge_u32 s3, 4
    s_cbranch_scc1 L_A_end
    v_lshl_add_u32 v33, v2, 3, v3
    s_and_b32 s54, s10, 7
    s_lshl_b32 s58, s3, 9
    v_lshl_add_u32 v5, v1, 6, v16
    s_lshl_b32 s57, s10, 11
    s_add_u32 s57, s57, 65536
    s_add_u32 s56, s57, s58
    v_add_u32 v25, s56, v5
    s_lshl_b32 s56, s10, 10
    s_add_u32 s56, s56, s63
    s_add_u32 s56, s56, 32768
    v_add_u32 v31, s56, v5
    v_lshlrev_b32 v5, 4, v3
    v_and_b32 v6, 2, v0
    v_lshl_add_u32 v5, v6, 2, v5
    v_lshl_add_u32 v5, v2, 1, v5
    v_and_b32 v6, 1, v0
    v_add_u32 v5, v5, v6
    s_lshl_b32 s56, s54, 8
    v_lshl_add_u32 v5, v5, 4, s56
    v_and_b32 v5, 2047, v5
    v_add_u32 v27, 6144, v5
    v_add_u32 v26, 2048, v5
    v_xor_b32 v5, 1024, v5
    v_add_u32 v28, 6144, v5
    v_and_b32 v5, 1, v2
    v_lshl_add_u32 v5, v5, 2, v3
    v_lshlrev_b32 v5, 5, v5
    v_add_u32 v6, s62, v15
    v_xor_b32 v6, v6, v5
    v_lshl_add_u32 v29, v33, 9, v6
    v_add_u32 v29, 0, v29
    v_and_b32 v5, 1, v2
    v_lshl_add_u32 v5, v5, 3, v3
    v_lshl_add_u32 v30, v5, 10, v15
    v_lshrrev_b32 v6, 1, v2
    v_lshl_add_u32 v30, v6, 5, v30
    s_add_u32 s56, s63, 32768
    v_add_u32 v30, s56, v30
    v_and_b32 v5, 1, v2
    v_lshl_add_u32 v5, v3, 1, v5
    v_lshlrev_b32 v5, 5, v5
    v_xor_b32 v30, v30, v5
    v_bfe_u32 v5, v0, 2, 1
    v_lshrrev_b32 v32, 3, v0
    v_lshl_add_u32 v32, v5, 3, v32
    v_lshlrev_b32 v32, 10, v32
    v_lshl_add_u32 v32, v4, 4, v32
    s_lshl_b32 s56, s10, 6
    s_add_u32 s56, s56, 32768
    v_add_u32 v32, s56, v32
    v_cmp_eq_u32 vcc, 0, v1
    s_nop 1
    v_cndmask_b32 v34, 0, -1, vcc
    v_cmp_eq_u32 vcc, 1, v1
    s_nop 1
    v_cndmask_b32 v35, 0, -1, vcc
    v_cmp_eq_u32 vcc, 2, v1
    s_nop 1
    v_cndmask_b32 v36, 0, -1, vcc
    v_cmp_eq_u32 vcc, 3, v1
    s_nop 1
    v_cndmask_b32 v37, 0, -1, vcc
    v_cmp_eq_u32 vcc, v6, v1
    s_nop 1
    v_cndmask_b32 v38, 0, -1, vcc
    v_add_u32 v6, 2, v6
    v_cmp_eq_u32 vcc, v6, v1
    s_nop 1
    v_cndmask_b32 v39, 0, -1, vcc
    v_add_u32 v6, 2, v6
    v_cmp_eq_u32 vcc, v6, v1
    s_nop 1
    v_cndmask_b32 v40, 0, -1, vcc
    v_add_u32 v6, 2, v6
    v_cmp_eq_u32 vcc, v6, v1
    s_nop 1
    v_cndmask_b32 v41, 0, -1, vcc
    s_mov_b32 s12, 0xf000f
    s_cmp_eq_u32 s3, 3
    s_cselect_b32 s12, 0x30003, s12
    global_load_dword v17, v27, s[44:45] sc1
    global_load_dword v17, v28, s[44:45] sc1
    s_mov_b32 s14, 2000000
W_17:
    ds_read_b32 v5, v10 offset:0
    s_waitcnt lgkmcnt(0)
    v_readfirstlane_b32 s15, v5
    s_cmp_ge_u32 s15, 18
    s_cbranch_scc1 AG_19
    s_sleep 1
    s_sub_u32 s14, s14, 1
    s_cbranch_scc0 W_17
    s_branch L_fail
AG_19:
OK_18:
    global_load_dwordx4 v[100:103], v26, s[44:45] sc1
    global_load_dwordx4 v[104:107], v26, s[44:45] offset:2048 sc1
    v_xor_b32 v6, 0, v29
    ds_read_b64_tr_b16 v[44:45], v6 offset:0
    ds_read_b64_tr_b16 v[46:47], v6 offset:2048
    ds_read_b64_tr_b16 v[48:49], v6 offset:16384
    ds_read_b64_tr_b16 v[50:51], v6 offset:18432
    v_xor_b32 v6, 32, v29
    ds_read_b64_tr_b16 v[52:53], v6 offset:0
    ds_read_b64_tr_b16 v[54:55], v6 offset:2048
    ds_read_b64_tr_b16 v[56:57], v6 offset:16384
    ds_read_b64_tr_b16 v[58:59], v6 offset:18432
    s_waitcnt lgkmcnt(4)
    v_xor_b32 v6, 64, v29
    ds_read_b64_tr_b16 v[60:61], v6 offset:0
    ds_read_b64_tr_b16 v[62:63], v6 offset:2048
    ds_read_b64_tr_b16 v[64:65], v6 offset:16384
    ds_read_b64_tr_b16 v[66:67], v6 offset:18432
    v_xor_b32 v6, 96, v29
    ds_read_b64_tr_b16 v[68:69], v6 offset:0
    ds_read_b64_tr_b16 v[70:71], v6 offset:2048
    ds_read_b64_tr_b16 v[72:73], v6 offset:16384
    ds_read_b64_tr_b16 v[74:75], v6 offset:18432
    s_mov_b32 s14, 2000000
W_20:
    ds_read_b32 v5, v10 offset:0
    s_waitcnt lgkmcnt(0)
    v_readfirstlane_b32 s15, v5
    s_cmp_ge_u32 s15, 19
    s_cbranch_scc1 AG_22
    s_sub_u32 s14, s14, 1
    s_cbranch_scc0 W_20
    s_branch L_fail
AG_22:
OK_21:
    v_xor_b32 v6, 0, v30
    ds_read_b64_tr_b16 v[76:77], v6
    ds_read_b64_tr_b16 v[78:79], v6 offset:4096
    v_xor_b32 v6, 64, v30
    ds_read_b64_tr_b16 v[80:81], v6
    ds_read_b64_tr_b16 v[82:83], v6 offset:4096
    v_xor_b32 v6, 128, v30
    ds_read_b64_tr_b16 v[84:85], v6
    ds_read_b64_tr_b16 v[86:87], v6 offset:4096
    v_xor_b32 v6, 192, v30
    ds_read_b64_tr_b16 v[88:89], v6
    ds_read_b64_tr_b16 v[90:91], v6 offset:4096
    s_mov_b32 s14, 2000000
    s_branch PW_25
P_23:
    global_load_dwordx4 v[100:103], v26, s[44:45] sc1
    global_load_dwordx4 v[104:107], v26, s[44:45] offset:2048 sc1
PW_25:
    s_waitcnt vmcnt(0)
    v_xor_b32 v92, s8, v100
    v_xor_b32 v93, s8, v101
    v_xor_b32 v94, s8, v102
    v_xor_b32 v95, s8, v103
    v_xor_b32 v96, s8, v104
    v_xor_b32 v97, s8, v105
    v_xor_b32 v98, s8, v106
    v_xor_b32 v99, s8, v107
    v_or3_b32 v9, v92, v93, v94
    v_or3_b32 v9, v9, v95, v96
    v_or3_b32 v9, v9, v97, v98
    v_or_b32 v9, v9, v99
    v_and_b32 v9, 0xffff, v9
    v_cmp_ne_u32 vcc, 0, v9
    s_cbranch_vccz OK_24
    s_sub_u32 s14, s14, 1
    s_cbranch_scc0 P_23
    s_branch L_fail
OK_24:
    s_waitcnt lgkmcnt(0)
    s_mov_b32 s14, 2000000
P_26:
    global_load_dwordx4 v[100:103], v27, s[44:45] sc1
    global_load_dwordx4 v[104:107], v28, s[44:45] sc1
PW_28:
    s_waitcnt vmcnt(0)
    v_xor_b32 v116, s8, v100
    v_xor_b32 v117, s8, v101
    v_xor_b32 v118, s8, v102
    v_xor_b32 v119, s8, v103
    v_xor_b32 v120, s8, v104
    v_xor_b32 v121, s8, v105
    v_xor_b32 v122, s8, v106
    v_xor_b32 v123, s8, v107
    v_or3_b32 v9, v116, v117, v118
    v_or3_b32 v9, v9, v119, v120
    v_or3_b32 v9, v9, v121, v122
    v_or_b32 v9, v9, v123
    v_and_b32 v9, 0xffff, v9
    v_cmp_ne_u32 vcc, 0, v9
    s_cbranch_vccz OK_27
    s_sub_u32 s14, s14, 1
    s_cbranch_scc0 P_26
    s_branch L_fail
OK_27:
    v_add_f32 v140, v116, v117
    v_mul_f32 v141, v116, v116
    v_add_f32 v5, v118, v119
    v_mul_f32 v6, v117, v117
    v_fmac_f32 v141, v118, v118
    v_fmac_f32 v6, v119, v119
    v_fmac_f32 v141, v120, v120
    v_fmac_f32 v6, v121, v121
    v_fmac_f32 v141, v122, v122
    v_fmac_f32 v6, v123, v123
    v_add_f32 v7, v120, v121
    v_add_f32 v8, v122, v123
    v_add_f32 v140, v140, v5
    v_add_f32 v7, v7, v8
    v_add_f32 v141, v141, v6
    v_add_f32 v140, v140, v7
    s_nop 1
    v_permlane32_swap_b32 v140, v141
    v_add_f32 v140, v140, v141
    v_mov_b32 v141, v140
    s_nop 1
    v_permlane16_swap_b32 v140, v141
    v_add_f32 v140, v140, v141
    s_nop 1
    v_add_f32_dpp v140, v140, v140 row_ror:8 row_mask:0xf bank_mask:0xf
    s_nop 1
    v_add_f32_dpp v140, v140, v140 row_ror:4 row_mask:0xf bank_mask:0xf
    s_nop 1
    v_add_f32_dpp v140, v140, v140 row_ror:2 row_mask:0xf bank_mask:0xf
    s_nop 1
    v_add_f32_dpp v140, v140, v140 row_ror:1 row_mask:0xf bank_mask:0xf
    v_mul_f32 v140, 0x3b000000, v140
    v_mov_b32 v141, v140
    s_nop 1
    v_permlane32_swap_b32 v140, v141
    v_fma_f32 v141, -v140, v140, v141
    v_max_f32 v141, 0, v141
    v_add_f32 v141, 0x3727c5ac, v141
    v_rsq_f32 v141, v141
    v_sub_f32 v116, v116, v140
    v_sub_f32 v117, v117, v140
    v_sub_f32 v118, v118, v140
    v_sub_f32 v119, v119, v140
    v_mul_f32 v96, v141, v96
    v_mul_f32 v97, v141, v97
    v_mul_f32 v98, v141, v98
    v_mul_f32 v99, v141, v99
    v_fma_f32 v116, v116, v96, v92
    v_fma_f32 v117, v117, v97, v93
    v_fma_f32 v118, v118, v98, v94
    v_fma_f32 v119, v119, v99, v95
    v_cvt_pk_bf16_f32 v124, v116, v117
    v_cvt_pk_bf16_f32 v125, v118, v119
    s_nop 0
    v_and_b32_dpp v128, v124, v34 row_newbcast:0 row_mask:0xf bank_mask:0xf
    v_and_b32_dpp v129, v125, v34 row_newbcast:0 row_mask:0xf bank_mask:0xf
    v_and_b32_dpp v130, v124, v34 row_newbcast:1 row_mask:0xf bank_mask:0xf
    v_and_b32_dpp v131, v125, v34 row_newbcast:1 row_mask:0xf bank_mask:0xf
    s_nop 1
    v_mfma_f32_16x16x32_bf16 v[136:139], v[44:47], v[128:131], 0
    v_and_b32_dpp v132, v124, v34 row_newbcast:2 row_mask:0xf bank_mask:0xf
    v_and_b32_dpp v133, v125, v34 row_newbcast:2 row_mask:0xf bank_mask:0xf
    v_and_b32_dpp v134, v124, v34 row_newbcast:3 row_mask:0xf bank_mask:0xf
    v_and_b32_dpp v135, v125, v34 row_newbcast:3 row_mask:0xf bank_mask:0xf
    s_nop 1
    v_mfma_f32_16x16x32_bf16 v[136:139], v[48:51], v[132:135], v[136:139]
    v_and_b32_dpp v128, v124, v35 row_newbcast:0 row_mask:0xf bank_mask:0xf
    v_and_b32_dpp v129, v125, v35 row_newbcast:0 row_mask:0xf bank_mask:0xf
    v_and_b32_dpp v130, v124, v35 row_newbcast:1 row_mask:0xf bank_mask:0xf
    v_and_b32_dpp v131, v125, v35 row_newbcast:1 row_mask:0xf bank_mask:0xf
    s_nop 1
    v_mfma_f32_16x16x32_bf16 v[136:139], v[52:55], v[128:131], v[136:139]
    v_and_b32_dpp v132, v124, v35 row_newbcast:2 row_mask:0xf bank_mask:0xf
    v_and_b32_dpp v133, v125, v35 row_newbcast:2 row_mask:0xf bank_mask:0xf
    v_and_b32_dpp v134, v124, v35 row_newbcast:3 row_mask:0xf bank_mask:0xf
    v_and_b32_dpp v135, v125, v35 row_newbcast:3 row_mask:0xf bank_mask:0xf
    s_nop 1
    v_mfma_f32_16x16x32_bf16 v[136:139], v[56:59], v[132:135], v[136:139]
    s_cmp_eq_u32 s3, 3
    s_cbranch_scc1 S_29
    v_and_b32_dpp v128, v124, v36 row_newbcast:0 row_mask:0xf bank_mask:0xf
    v_and_b32_dpp v129, v125, v36 row_newbcast:0 row_mask:0xf bank_mask:0xf
    v_and_b32_dpp v130, v124, v36 row_newbcast:1 row_mask:0xf bank_mask:0xf
    v_and_b32_dpp v131, v125, v36 row_newbcast:1 row_mask:0xf bank_mask:0xf
    s_nop 1
    v_mfma_f32_16x16x32_bf16 v[136:139], v[60:63], v[128:131], v[136:139]
    v_and_b32_dpp v132, v124, v36 row_newbcast:2 row_mask:0xf bank_mask:0xf
    v_and_b32_dpp v133, v125, v36 row_newbcast:2 row_mask:0xf bank_mask:0xf
    v_and_b32_dpp v134, v124, v36 row_newbcast:3 row_mask:0xf bank_mask:0xf
    v_and_b32_dpp v135, v125, v36 row_newbcast:3 row_mask:0xf bank_mask:0xf
    s_nop 1
    v_mfma_f32_16x16x32_bf16 v[136:139], v[64:67], v[132:135], v[136:139]
    v_and_b32_dpp v128, v124, v37 row_newbcast:0 row_mask:0xf bank_mask:0xf
    v_and_b32_dpp v129, v125, v37 row_newbcast:0 row_mask:0xf bank_mask:0xf
    v_and_b32_dpp v130, v124, v37 row_newbcast:1 row_mask:0xf bank_mask:0xf
    v_and_b32_dpp v131, v125, v37 row_newbcast:1 row_mask:0xf bank_mask:0xf
    s_nop 1
    v_mfma_f32_16x16x32_bf16 v[136:139], v[68:71], v[128:131], v[136:139]
    v_and_b32_dpp v132, v124, v37 row_newbcast:2 row_mask:0xf bank_mask:0xf
    v_and_b32_dpp v133, v125, v37 row_newbcast:2 row_mask:0xf bank_mask:0xf
    v_and_b32_dpp v134, v124, v37 row_newbcast:3 row_mask:0xf bank_mask:0xf
    v_and_b32_dpp v135, v125, v37 row_newbcast:3 row_mask:0xf bank_mask:0xf
    s_nop 1
    v_mfma_f32_16x16x32_bf16 v[136:139], v[72:75], v[132:135], v[136:139]
S_29:
    s_nop 7
    v_and_or_b32 v136, v136, s47, v12
    v_and_or_b32 v137, v137, s47, v12
    v_and_or_b32 v138, v138, s47, v12
    v_and_or_b32 v139, v139, s47, v12
    s_mov_b32 exec_lo, s12
    s_mov_b32 exec_hi, s12
    s_cmp_eq_u32 s46, 1
    s_cbranch_scc0 SL_30
    global_store_dwordx4 v31, v[136:139], s[44:45]
BK_31:
    s_mov_b64 exec, -1
    s_cmp_ge_u32 s10, 14
    s_cbranch_scc1 L_A_zero
    s_mov_b32 s14, 2000000
    global_load_dwordx4 v[100:103], v32, s[44:45] sc1
    s_sleep 2
PP_32:
    global_load_dwordx4 v[108:111], v32, s[44:45] sc1
    s_waitcnt vmcnt(1)
    v_xor_b32 v116, s9, v100
    v_xor_b32 v117, s9, v101
    v_xor_b32 v118, s9, v102
    v_xor_b32 v119, s9, v103
    v_or3_b32 v9, v116, v117, v118
    v_or_b32 v9, v9, v119
    v_and_b32 v9, 0x3f, v9
    v_cmp_ne_u32 vcc, 0, v9
    s_cbranch_vccz OK_33
    global_load_dwordx4 v[100:103], v32, s[44:45] sc1
    s_waitcnt vmcnt(1)
    v_xor_b32 v116, s9, v108
    v_xor_b32 v117, s9, v109
    v_xor_b32 v118, s9, v110
    v_xor_b32 v119, s9, v111
    v_or3_b32 v9, v116, v117, v118
    v_or_b32 v9, v9, v119
    v_and_b32 v9, 0x3f, v9
    v_cmp_ne_u32 vcc, 0, v9
    s_cbranch_vccz OK_33
    s_sub_u32 s14, s14, 1
    s_cbranch_scc0 PP_32
    s_branch L_fail
OK_33:
    v_permlane32_swap_b32 v116, v117
    v_permlane32_swap_b32 v118, v119
    v_add_f32 v116, v116, v117
    v_add_f32 v118, v118, v119
    s_nop 1
    v_permlane16_swap_b32 v116, v118
    v_add_f32 v116, v116, v118
    s_nop 1
    v_add_f32_dpp v116, v116, v116 row_ror:8 row_mask:0xf bank_mask:0xf
    v_cvt_pk_bf16_f32 v116, v116, v116
    v_and_b32 v116, s49, v116
    v_mul_f32 v5, s50, v116
    v_exp_f32 v5, -v5
    s_nop 0
    v_add_f32 v5, 1.0, v5
    v_rcp_f32 v5, v5
    s_nop 0
    v_cvt_pk_bf16_f32 v5, v5, v5
    v_and_b32 v5, s49, v5
    s_nop 1
    v_mul_f32_dpp v5, v116, v5 row_ror:12 row_mask:0xf bank_mask:0xf
    v_mov_b32 v6, v5
    s_nop 1
    v_permlane32_swap_b32 v5, v6
    v_cvt_pk_bf16_f32 v5, v5, v6
    v_mov_b32 v6, v5
    s_nop 1
    v_permlane16_swap_b32 v5, v6
    s_nop 1
    v_mov_b32_dpp v92, v5 row_newbcast:0 row_mask:0x5 bank_mask:0xf
    v_mov_b32_dpp v93, v6 row_newbcast:0 row_mask:0x5 bank_mask:0xf
    v_mov_b32_dpp v94, v5 row_newbcast:1 row_mask:0x5 bank_mask:0xf
    v_mov_b32_dpp v95, v6 row_newbcast:1 row_mask:0x5 bank_mask:0xf
    v_mov_b32_dpp v92, v5 row_newbcast:2 row_mask:0xa bank_mask:0xf
    v_mov_b32_dpp v93, v6 row_newbcast:2 row_mask:0xa bank_mask:0xf
    v_mov_b32_dpp v94, v5 row_newbcast:3 row_mask:0xa bank_mask:0xf
    v_mov_b32_dpp v95, v6 row_newbcast:3 row_mask:0xa bank_mask:0xf
    v_and_b32 v128, v38, v92
    v_and_b32 v129, v38, v93
    v_and_b32 v130, v38, v94
    v_and_b32 v131, v38, v95
    s_nop 1
    v_mfma_f32_16x16x32_bf16 v[136:139], v[76:79], v[128:131], 0
    v_and_b32 v132, v39, v92
    v_and_b32 v133, v39, v93
    v_and_b32 v134, v39, v94
    v_and_b32 v135, v39, v95
    s_nop 1
    v_mfma_f32_16x16x32_bf16 v[136:139], v[80:83], v[132:135], v[136:139]
    v_and_b32 v128, v40, v92
    v_and_b32 v129, v40, v93
    v_and_b32 v130, v40, v94
    v_and_b32 v131, v40, v95
    s_nop 1
    v_mfma_f32_16x16x32_bf16 v[136:139], v[84:87], v[128:131], v[136:139]
    v_and_b32 v132, v41, v92
    v_and_b32 v133, v41, v93
    v_and_b32 v134, v41, v94
    v_and_b32 v135, v41, v95
    s_nop 1
    v_mfma_f32_16x16x32_bf16 v[136:139], v[88:91], v[132:135], v[136:139]
    s_nop 7
    v_and_or_b32 v136, v136, s47, v12
    v_and_or_b32 v137, v137, s47, v12
    v_and_or_b32 v138, v138, s47, v12
    v_and_or_b32 v139, v139, s47, v12
L_A_pub:
    s_mov_b32 exec_lo, 0xff00ff
    s_mov_b32 exec_hi, 0xff00ff
    s_cmp_eq_u32 s46, 1
    s_cbranch_scc0 SL_34
    global_store_dwordx4 v25, v[136:139], s[44:45]
BK_35:
    s_mov_b64 exec, -1
L_A_end:
    s_endpgm
L_A_zero:
    v_mov_b32 v136, v12
    v_mov_b32 v137, v12
    v_mov_b32 v138, v12
    v_mov_b32 v139, v12
    s_branch L_A_pub
L_A_vlate:
    s_cmp_eq_u32 s13, 1
    s_cbranch_scc1 S_36
    s_mov_b32 s14, 2000000
W_37:
    ds_read_b32 v5, v10 offset:0
    s_waitcnt lgkmcnt(0)
    v_readfirstlane_b32 s15, v5
    s_cmp_ge_u32 s15, 14
    s_cbranch_scc1 AG_39
    s_sub_u32 s14, s14, 1
    s_cbranch_scc0 W_37
    s_branch L_fail
AG_39:
OK_38:
    ds_read_b64_tr_b16 v[68:69], v32 offset:0
    ds_read_b64_tr_b16 v[70:71], v32 offset:4096
    ds_read_b64_tr_b16 v[72:73], v32 offset:8192
    ds_read_b64_tr_b16 v[74:75], v32 offset:12288
    ds_read_b64_tr_b16 v[76:77], v32 offset:16384
    ds_read_b64_tr_b16 v[78:79], v32 offset:20480
    ds_read_b64_tr_b16 v[80:81], v32 offset:24576
    ds_read_b64_tr_b16 v[82:83], v32 offset:28672
    ds_read_b64_tr_b16 v[84:85], v32 offset:32768
    ds_read_b64_tr_b16 v[86:87], v32 offset:36864
S_36:
    s_waitcnt lgkmcnt(0)
    ds_read_b32 v7, v10
    ds_read_b64_tr_b16 v[88:89], v32 offset:40960
    ds_read_b64_tr_b16 v[90:91], v32 offset:45056
    ds_read_b64_tr_b16 v[92:93], v32 offset:49152
    ds_read_b64_tr_b16 v[94:95], v32 offset:53248
    v_mfma_f32_16x16x32_bf16 v[112:115], v[68:71], v[36:39], 0
    v_mfma_f32_16x16x32_bf16 v[112:115], v[72:75], v[40:43], v[112:115]
    v_mfma_f32_16x16x32_bf16 v[112:115], v[76:79], v[44:47], v[112:115]
    v_mfma_f32_16x16x32_bf16 v[112:115], v[80:83], v[48:51], v[112:115]
    v_mfma_f32_16x16x32_bf16 v[112:115], v[84:87], v[52:55], v[112:115]
    s_waitcnt lgkmcnt(4)
    v_readfirstlane_b32 s15, v7
    s_cmp_ge_u32 s15, 16
    s_cbranch_scc1 S_40
    s_mov_b32 s14, 2000000
W_41:
    ds_read_b32 v5, v10 offset:0
    s_waitcnt lgkmcnt(0)
    v_readfirstlane_b32 s15, v5
    s_cmp_ge_u32 s15, 16
    s_cbranch_scc1 AG_43
    s_sub_u32 s14, s14, 1
    s_cbranch_scc0 W_41
    s_branch L_fail
AG_43:
OK_42:
    ds_read_b64_tr_b16 v[88:89], v32 offset:40960
    ds_read_b64_tr_b16 v[90:91], v32 offset:45056
    ds_read_b64_tr_b16 v[92:93], v32 offset:49152
    ds_read_b64_tr_b16 v[94:95], v32 offset:53248
S_40:
    ds_read_b32 v7, v10
    ds_read_b64_tr_b16 v[96:97], v32 offset:57344
    ds_read_b64_tr_b16 v[98:99], v32 offset:61440
    s_waitcnt lgkmcnt(5)
    v_mfma_f32_16x16x32_bf16 v[112:115], v[88:91], v[56:59], v[112:115]
    s_waitcnt lgkmcnt(3)
    v_mfma_f32_16x16x32_bf16 v[112:115], v[92:95], v[60:63], v[112:115]
    s_mov_b32 s14, 2000000
W_44:
    s_waitcnt lgkmcnt(2)
    v_readfirstlane_b32 s15, v7
    s_cmp_ge_u32 s15, 17
    s_cbranch_scc1 OK_45
    ds_read_b32 v7, v10
    ds_read_b64_tr_b16 v[96:97], v32 offset:57344
    ds_read_b64_tr_b16 v[98:99], v32 offset:61440
    s_sub_u32 s14, s14, 1
    s_cbranch_scc0 W_44
    s_branch L_fail
OK_45:
    s_waitcnt lgkmcnt(0)
    v_mfma_f32_16x16x32_bf16 v[112:115], v[96:99], v[64:67], v[112:115]
    s_branch L_A_pvdone
L_A9:
    v_lshlrev_b32 v25, 4, v0
    v_add_u32 v25, 12288, v25
    v_lshrrev_b32 v5, 5, v0
    v_mul_u32_u24 v5, 320, v5
    v_and_b32 v6, 31, v0
    v_lshl_add_u32 v26, v6, 3, v5
    v_add_u32 v26, 157696, v26
    s_barrier
    s_waitcnt lgkmcnt(0)
    s_add_u32 s6, s6, 1
    s_and_b32 s7, s6, 0x3f
    s_and_b32 s8, s6, 0xffff
    s_xor_b32 s9, s7, 0x20
    v_mov_b32 v11, s7
    v_mov_b32 v12, s9
    s_mul_i32 s52, s52, 0x01010101
    v_and_b32 v6, 7, v0
    s_lshl_b32 s56, s4, 5
    v_lshl_add_u32 v6, v6, 2, s56
    s_mov_b32 s14, 40
PP_46:
    global_load_dword v5, v6, s[40:41] sc1
    s_waitcnt vmcnt(0)
    v_cmp_ne_u32 vcc, s52, v5
    s_cbranch_vccz PP_46_ok
    s_sub_u32 s14, s14, 1
    s_cbranch_scc0 PP_46
    s_branch PD_47
PP_46_ok:
    ds_write_b32 v10, v14 offset:52
PD_47:
    s_mov_b32 s14, 2000000
W_48:
    ds_read_b32 v5, v10 offset:0
    s_waitcnt lgkmcnt(0)
    v_readfirstlane_b32 s15, v5
    s_cmp_ge_u32 s15, 4
    s_cbranch_scc1 AG_50
    s_sleep 1
    s_sub_u32 s14, s14, 1
    s_cbranch_scc0 W_48
    s_branch L_fail
AG_50:
OK_49:
    s_mov_b32 s14, 2000000
    global_load_dwordx4 v[28:31], v25, s[44:45] offset:0 sc1
    global_load_dwordx4 v[32:35], v25, s[44:45] offset:1024 sc1
    global_load_dwordx4 v[36:39], v25, s[44:45] offset:2048 sc1
    global_load_dwordx4 v[40:43], v25, s[44:45] offset:3072 sc1
    s_sleep 8
    global_load_dwordx4 v[44:47], v25, s[44:45] offset:0 sc1
    global_load_dwordx4 v[48:51], v25, s[44:45] offset:1024 sc1
    global_load_dwordx4 v[52:55], v25, s[44:45] offset:2048 sc1
    global_load_dwordx4 v[56:59], v25, s[44:45] offset:3072 sc1
    s_sleep 8
    global_load_dwordx4 v[60:63], v25, s[44:45] offset:0 sc1
    global_load_dwordx4 v[64:67], v25, s[44:45] offset:1024 sc1
    global_load_dwordx4 v[68:71], v25, s[44:45] offset:2048 sc1
    global_load_dwordx4 v[72:75], v25, s[44:45] offset:3072 sc1
    s_sleep 8
PP_51:
    global_load_dwordx4 v[76:79], v25, s[44:45] offset:0 sc1
    global_load_dwordx4 v[80:83], v25, s[44:45] offset:1024 sc1
    global_load_dwordx4 v[84:87], v25, s[44:45] offset:2048 sc1
    global_load_dwordx4 v[88:91], v25, s[44:45] offset:3072 sc1
    s_waitcnt vmcnt(12)
    v_xor_b32 v92, s7, v28
    v_xor_b32 v93, s7, v29
    v_xor_b32 v94, s7, v30
    v_xor_b32 v95, s7, v31
    v_xor_b32 v96, s7, v32
    v_xor_b32 v97, s7, v33
    v_xor_b32 v98, s7, v34
    v_xor_b32 v99, s7, v35
    v_xor_b32 v100, s7, v36
    v_xor_b32 v101, s7, v37
    v_xor_b32 v102, s7, v38
    v_xor_b32 v103, s7, v39
    v_xor_b32 v104, s7, v40
    v_xor_b32 v105, s7, v41
    v_xor_b32 v106, s7, v42
    v_xor_b32 v107, s7, v43
    v_or3_b32 v9, v92, v93, v94
    v_or3_b32 v9, v9, v95, v96
    v_or3_b32 v9, v9, v97, v98
    v_or3_b32 v9, v9, v99, v100
    v_or3_b32 v9, v9, v101, v102
    v_or3_b32 v9, v9, v103, v104
    v_or3_b32 v9, v9, v105, v106
    v_or_b32 v9, v9, v107
    v_and_b32 v9, 0x3f, v9
    v_cmp_ne_u32 vcc, 0, v9
    s_cbranch_vccz OK_52
    global_load_dwordx4 v[28:31], v25, s[44:45] offset:0 sc1
    global_load_dwordx4 v[32:35], v25, s[44:45] offset:1024 sc1
    global_load_dwordx4 v[36:39], v25, s[44:45] offset:2048 sc1
    global_load_dwordx4 v[40:43], v25, s[44:45] offset:3072 sc1
    s_waitcnt vmcnt(12)
    v_xor_b32 v92, s7, v44
    v_xor_b32 v93, s7, v45
    v_xor_b32 v94, s7, v46
    v_xor_b32 v95, s7, v47
    v_xor_b32 v96, s7, v48
    v_xor_b32 v97, s7, v49
    v_xor_b32 v98, s7, v50
    v_xor_b32 v99, s7, v51
    v_xor_b32 v100, s7, v52
    v_xor_b32 v101, s7, v53
    v_xor_b32 v102, s7, v54
    v_xor_b32 v103, s7, v55
    v_xor_b32 v104, s7, v56
    v_xor_b32 v105, s7, v57
    v_xor_b32 v106, s7, v58
    v_xor_b32 v107, s7, v59
    v_or3_b32 v9, v92, v93, v94
    v_or3_b32 v9, v9, v95, v96
    v_or3_b32 v9, v9, v97, v98
    v_or3_b32 v9, v9, v99, v100
    v_or3_b32 v9, v9, v101, v102
    v_or3_b32 v9, v9, v103, v104
    v_or3_b32 v9, v9, v105, v106
    v_or_b32 v9, v9, v107
    v_and_b32 v9, 0x3f, v9
    v_cmp_ne_u32 vcc, 0, v9
    s_cbranch_vccz OK_52
    global_load_dwordx4 v[44:47], v25, s[44:45] offset:0 sc1
    global_load_dwordx4 v[48:51], v25, s[44:45] offset:1024 sc1
    global_load_dwordx4 v[52:55], v25, s[44:45] offset:2048 sc1
    global_load_dwordx4 v[56:59], v25, s[44:45] offset:3072 sc1
    s_waitcnt vmcnt(12)
    v_xor_b32 v92, s7, v60
    v_xor_b32 v93, s7, v61
    v_xor_b32 v94, s7, v62
    v_xor_b32 v95, s7, v63
    v_xor_b32 v96, s7, v64
    v_xor_b32 v97, s7, v65
    v_xor_b32 v98, s7, v66
    v_xor_b32 v99, s7, v67
    v_xor_b32 v100, s7, v68
    v_xor_b32 v101, s7, v69
    v_xor_b32 v102, s7, v70
    v_xor_b32 v103, s7, v71
    v_xor_b32 v104, s7, v72
    v_xor_b32 v105, s7, v73
    v_xor_b32 v106, s7, v74
    v_xor_b32 v107, s7, v75
    v_or3_b32 v9, v92, v93, v94
    v_or3_b32 v9, v9, v95, v96
    v_or3_b32 v9, v9, v97, v98
    v_or3_b32 v9, v9, v99, v100
    v_or3_b32 v9, v9, v101, v102
    v_or3_b32 v9, v9, v103, v104
    v_or3_b32 v9, v9, v105, v106
    v_or_b32 v9, v9, v107
    v_and_b32 v9, 0x3f, v9
    v_cmp_ne_u32 vcc, 0, v9
    s_cbranch_vccz OK_52
    global_load_dwordx4 v[60:63], v25, s[44:45] offset:0 sc1
    global_load_dwordx4 v[64:67], v25, s[44:45] offset:1024 sc1
    global_load_dwordx4 v[68:71], v25, s[44:45] offset:2048 sc1
    global_load_dwordx4 v[72:75], v25, s[44:45] offset:3072 sc1
    s_waitcnt vmcnt(12)
    v_xor_b32 v92, s7, v76
    v_xor_b32 v93, s7, v77
    v_xor_b32 v94, s7, v78
    v_xor_b32 v95, s7, v79
    v_xor_b32 v96, s7, v80
    v_xor_b32 v97, s7, v81
    v_xor_b32 v98, s7, v82
    v_xor_b32 v99, s7, v83
    v_xor_b32 v100, s7, v84
    v_xor_b32 v101, s7, v85
    v_xor_b32 v102, s7, v86
    v_xor_b32 v103, s7, v87
    v_xor_b32 v104, s7, v88
    v_xor_b32 v105, s7, v89
    v_xor_b32 v106, s7, v90
    v_xor_b32 v107, s7, v91
    v_or3_b32 v9, v92, v93, v94
    v_or3_b32 v9, v9, v95, v96
    v_or3_b32 v9, v9, v97, v98
    v_or3_b32 v9, v9, v99, v100
    v_or3_b32 v9, v9, v101, v102
    v_or3_b32 v9, v9, v103, v104
    v_or3_b32 v9, v9, v105, v106
    v_or_b32 v9, v9, v107
    v_and_b32 v9, 0x3f, v9
    v_cmp_ne_u32 vcc, 0, v9
    s_cbranch_vccz OK_52
    s_sub_u32 s14, s14, 1
    s_cbranch_scc0 PP_51
    s_branch L_fail
OK_52:
    v_add_f32 v92, v92, v100
    v_add_f32 v93, v93, v101
    v_add_f32 v94, v94, v102
    v_add_f32 v95, v95, v103
    v_add_f32 v96, v96, v104
    v_add_f32 v97, v97, v105
    v_add_f32 v98, v98, v106
    v_add_f32 v99, v99, v107
    v_cvt_pk_bf16_f32 v108, v92, v93
    v_cvt_pk_bf16_f32 v109, v94, v95
    v_cvt_pk_bf16_f32 v110, v96, v97
    v_cvt_pk_bf16_f32 v111, v98, v99
    ds_write_b64 v26, v[108:109]
    ds_write_b64 v26, v[110:111] offset:640
    ds_write_b32 v10, v14 offset:56
    v_lshlrev_b32 v8, 5, v4
    v_add_u32 v8, 159232, v8
    s_lshl_b32 s56, s10, 6
    s_add_u32 s56, s56, 8192
    v_lshl_add_u32 v7, v0, 4, s56
    v_mov_b32 v106, s6
    v_mov_b32 v107, s6
    s_mov_b32 s14, 2000000
W_53:
    ds_read_b32 v5, v10 offset:48
    s_waitcnt lgkmcnt(0)
    v_readfirstlane_b32 s15, v5
    s_cmp_ge_u32 s15, 8
    s_cbranch_scc1 AG_55
    s_sleep 1
    s_sub_u32 s14, s14, 1
    s_cbranch_scc0 W_53
    s_branch L_fail
AG_55:
OK_54:
    ds_read_b128 v[92:95], v8
    ds_read_b128 v[96:99], v8 offset:16
    ds_read_b128 v[112:115], v8 offset:128
    ds_read_b128 v[116:119], v8 offset:144
    ds_read_b32 v13, v10 offset:52
    s_waitcnt lgkmcnt(0)
    v_readfirstlane_b32 s46, v13
    v_max3_f32 v104, v92, v93, v94
    v_max3_f32 v5, v95, v96, v97
    v_max3_f32 v104, v104, v98, v99
    v_max_f32 v104, v104, v5
    v_add_f32 v112, v112, v113
    v_add_f32 v114, v114, v115
    v_add_f32 v116, v116, v117
    v_add_f32 v118, v118, v119
    v_add_f32 v112, v112, v114
    v_add_f32 v116, v116, v118
    v_add_f32 v105, v112, v116
    v_and_or_b32 v104, v104, s47, v11
    v_and_or_b32 v105, v105, s47, v11
    s_mov_b64 exec, 15
    s_cmp_eq_u32 s46, 1
    s_cbranch_scc0 SL_56
    global_store_dwordx4 v7, v[104:107], s[44:45]
BK_57:
    s_mov_b64 exec, -1
    s_waitcnt vmcnt(0)
    s_lshr_b32 s56, s10, 1
    s_lshl_b32 s56, s56, 8
    s_and_b32 s57, s10, 1
    s_lshl_b32 s57, s57, 7
    s_add_u32 s56, s56, s57
    s_add_u32 s56, s56, 32768
    v_lshlrev_b32 v44, 11, v2
    v_lshl_add_u32 v44, v1, 2, v44
    v_add_u32 v44, s56, v44
    s_lshl_b32 s56, s10, 7
    v_lshl_add_u32 v45, v1, 2, s56
    v_lshrrev_b32 v5, 1, v2
    v_lshl_add_u32 v45, v5, 11, v45
    v_xor_b32 v5, v5, v2
    v_and_b32 v5, 1, v5
    v_mov_b32 v6, 25600
    v_mov_b32 v7, 2048
    v_cmp_eq_u32 vcc, 1, v5
    s_nop 1
    v_cndmask_b32 v6, v6, v7, vcc
    v_add_u32 v45, v45, v6
    s_mov_b32 s14, 2000000
P_58:
    global_load_dword v28, v44, s[42:43] sc1
    global_load_dword v32, v44, s[42:43] offset:64 sc1
    v_add_u32 v5, 8192, v44
    global_load_dword v29, v5, s[42:43] sc1
    global_load_dword v33, v5, s[42:43] offset:64 sc1
    v_add_u32 v5, 16384, v44
    global_load_dword v30, v5, s[42:43] sc1
    global_load_dword v34, v5, s[42:43] offset:64 sc1
    v_add_u32 v5, 24576, v44
    global_load_dword v31, v5, s[42:43] sc1
    global_load_dword v35, v5, s[42:43] offset:64 sc1
    s_waitcnt vmcnt(0)
    v_xor_b32 v36, s7, v28
    v_xor_b32 v37, s7, v29
    v_xor_b32 v38, s7, v30
    v_xor_b32 v39, s7, v31
    v_xor_b32 v40, s7, v32
    v_xor_b32 v41, s7, v33
    v_xor_b32 v42, s7, v34
    v_xor_b32 v43, s7, v35
    v_or3_b32 v9, v36, v37, v38
    v_or3_b32 v9, v9, v39, v40
    v_or3_b32 v9, v9, v41, v42
    v_or_b32 v9, v9, v43
    v_and_b32 v9, 0x3f, v9
    v_cmp_ne_u32 vcc, 0, v9
    s_cbranch_vccz OK_59
    s_sub_u32 s14, s14, 1
    s_cbranch_scc0 P_58
    s_branch L_fail
OK_59:
    v_cmp_eq_u32 vcc, 2, v2
    v_add_f32 v36, v36, v37
    v_add_f32 v38, v38, v39
    v_add_f32 v36, v36, v38
    v_cvt_pk_bf16_f32 v46, v36, v36
    v_and_b32 v46, s49, v46
    v_add_f32 v5, 1.0, v46
    v_cvt_pk_bf16_f32 v5, v5, v5
    v_and_b32 v5, s49, v5
    v_cndmask_b32 v46, v46, v5, vcc
    v_or_b32 v46, s8, v46
    v_add_f32 v40, v40, v41
    v_add_f32 v42, v42, v43
    v_add_f32 v40, v40, v42
    v_cvt_pk_bf16_f32 v47, v40, v40
    v_and_b32 v47, s49, v47
    v_add_f32 v5, 1.0, v47
    v_cvt_pk_bf16_f32 v5, v5, v5
    v_and_b32 v5, s49, v5
    v_cndmask_b32 v47, v47, v5, vcc
    v_or_b32 v47, s8, v47
    s_cmp_eq_u32 s46, 1
    s_cbranch_scc0 SL_60
    global_store_dword v45, v46, s[44:45]
    global_store_dword v45, v47, s[44:45] offset:64
BK_61:
    s_endpgm
L_W:
    s_mov_b32 s13, 0
    s_cmp_eq_u32 s3, 9
    s_cbranch_scc1 L_W9
    v_lshl_add_u32 v33, v2, 3, v3
    s_and_b32 s54, s10, 7
    s_lshr_b32 s55, s10, 3
    v_lshl_add_u32 v25, v33, 7, v15
    v_add_u32 v25, s60, v25
    s_lshl_b32 s56, s55, 10
    v_lshl_add_u32 v26, v0, 4, s56
    s_lshl_b32 s58, s3, 9
    s_add_u32 s56, s58, 157696
    v_lshl_add_u32 v27, v0, 3, s56
    v_add_u32 v28, s56, v16
    s_lshl_b32 s56, s55, 11
    s_lshl_b32 s57, s54, 8
    s_add_u32 s56, s56, s57
    s_add_u32 s56, s56, s61
    s_add_u32 s56, s56, 12288
    v_add_u32 v29, s56, v16
    v_and_b32 v5, 1, v2
    v_lshl_add_u32 v5, v5, 2, v3
    v_lshlrev_b32 v5, 5, v5
    v_add_u32 v6, s62, v15
    v_xor_b32 v6, v6, v5
    v_lshl_add_u32 v30, v33, 10, v6
    v_add_u32 v30, 32768, v30
    v_add_u32 v32, 159744, v16
    v_lshl_add_u32 v5, v1, 6, v16
    s_lshl_b32 s57, s10, 11
    s_add_u32 s57, s57, 65536
    s_add_u32 s56, s57, s63
    v_add_u32 v31, s56, v5
    v_cmp_eq_u32 vcc, 0, v1
    s_nop 1
    v_cndmask_b32 v35, 0, -1, vcc
    v_cmp_eq_u32 vcc, 1, v1
    s_nop 1
    v_cndmask_b32 v36, 0, -1, vcc
    v_cmp_eq_u32 vcc, 2, v1
    s_nop 1
    v_cndmask_b32 v37, 0, -1, vcc
    v_cmp_eq_u32 vcc, 3, v1
    s_nop 1
    v_cndmask_b32 v38, 0, -1, vcc
    s_barrier
    s_waitcnt lgkmcnt(0)
    s_add_u32 s6, s6, 1
    s_and_b32 s7, s6, 0x3f
    s_and_b32 s8, s6, 0xffff
    s_xor_b32 s9, s7, 0x20
    v_mov_b32 v11, s7
    v_mov_b32 v12, s9
    s_cmp_ge_u32 s3, 4
    s_cbranch_scc0 L_W_03
    s_lshl_b32 s56, s10, 3
    s_add_u32 s56, s56, s4
    s_lshl_b32 s56, s56, 8
    s_add_u32 s56, s56, s61
    s_add_u32 s56, s56, 32512
    v_add_u32 v39, s56, v16
    s_sub_u32 s56, s63, -159232
    v_lshl_add_u32 v7, v0, 2, s56
    v_add_u32 v77, s56, v16
    s_sub_u32 s56, s60, -65408
    v_lshl_add_u32 v76, v2, 3, v3
    v_lshl_add_u32 v76, v76, 7, v15
    v_add_u32 v76, s56, v76
    s_waitcnt vmcnt(0)
    v_lshlrev_b32 v20, 16, v24
    v_and_b32 v21, s49, v24
    v_mul_f32 v5, s50, v20
    v_exp_f32 v5, -v5
    s_nop 0
    v_add_f32 v5, 1.0, v5
    v_rcp_f32 v22, v5
    s_nop 0
    v_mul_f32 v23, v20, v22
    v_fma_f32 v5, -v23, v5, v20
    v_fma_f32 v5, v5, v22, v23
    v_cmp_o_f32 vcc, v5, v5
    s_nop 1
    v_cndmask_b32 v20, v23, v5, vcc
    v_mul_f32 v6, s50, v21
    v_exp_f32 v6, -v6
    s_nop 0
    v_add_f32 v6, 1.0, v6
    v_rcp_f32 v22, v6
    s_nop 0
    v_mul_f32 v23, v21, v22
    v_fma_f32 v6, -v23, v6, v21
    v_fma_f32 v6, v6, v22, v23
    v_cmp_o_f32 vcc, v6, v6
    s_nop 1
    v_cndmask_b32 v21, v23, v6, vcc
    v_cvt_pk_bf16_f32 v24, v20, v21
    ds_write_b32 v7, v24
    ds_read_b128 v[40:43], v77 offset:0
    ds_read_b128 v[44:47], v77 offset:64
    ds_read_b128 v[48:51], v77 offset:128
    ds_read_b128 v[52:55], v77 offset:192
    s_cmp_eq_u32 s3, 7
    s_cbranch_scc0 S_62
    s_lshl_b32 s56, s10, 3
    s_add_u32 s56, s56, s4
    s_lshl_b32 s56, s56, 7
    s_and_b32 s57, s56, 0x2000
    s_add_u32 s56, s56, s57
    s_add_u32 s56, s56, 1114112
    s_add_u32 s56, s42, s56
    s_addc_u32 s57, s43, 0
    s_mov_b32 s52, -1
    s_mov_b32 s53, -1
    s_memtime s[84:85]
    s_waitcnt lgkmcnt(0)
    s_load_dword s54, s[56:57], 0 glc
    s_waitcnt lgkmcnt(0)
    s_memtime s[86:87]
    s_waitcnt lgkmcnt(0)
    s_sub_u32 s54, s86, s84
    s_min_u32 s52, s52, s54
    s_memtime s[84:85]
    s_waitcnt lgkmcnt(0)
    s_load_dword s54, s[56:57], 8192 glc
    s_waitcnt lgkmcnt(0)
    s_memtime s[86:87]
    s_waitcnt lgkmcnt(0)
    s_sub_u32 s54, s86, s84
    s_min_u32 s53, s53, s54
    s_cmp_lt_u32 s52, s53
    s_cselect_b32 s54, 1, 2
    v_mov_b32 v5, s54
    ds_write_b32 v10, v5 offset:36
    s_memtime s[84:85]
    s_waitcnt lgkmcnt(0)
    s_load_dword s54, s[56:57], 0 glc
    s_waitcnt lgkmcnt(0)
    s_memtime s[86:87]
    s_waitcnt lgkmcnt(0)
    s_sub_u32 s54, s86, s84
    s_min_u32 s52, s52, s54
    s_memtime s[84:85]
    s_waitcnt lgkmcnt(0)
    s_load_dword s54, s[56:57], 8192 glc
    s_waitcnt lgkmcnt(0)
    s_memtime s[86:87]
    s_waitcnt lgkmcnt(0)
    s_sub_u32 s54, s86, s84
    s_min_u32 s53, s53, s54
    s_cmp_lt_u32 s52, s53
    s_cselect_b32 s54, 1, 2
    v_mov_b32 v5, s54
    ds_write_b32 v10, v5 offset:36
    s_memtime s[84:85]
    s_waitcnt lgkmcnt(0)
    s_load_dword s54, s[56:57], 0 glc
    s_waitcnt lgkmcnt(0)
    s_memtime s[86:87]
    s_waitcnt lgkmcnt(0)
    s_sub_u32 s54, s86, s84
    s_min_u32 s52, s52, s54
    s_memtime s[84:85]
    s_waitcnt lgkmcnt(0)
    s_load_dword s54, s[56:57], 8192 glc
    s_waitcnt lgkmcnt(0)
    s_memtime s[86:87]
    s_waitcnt lgkmcnt(0)
    s_sub_u32 s54, s86, s84
    s_min_u32 s53, s53, s54
    s_cmp_lt_u32 s52, s53
    s_cselect_b32 s54, 1, 2
    v_mov_b32 v5, s54
    ds_write_b32 v10, v5 offset:36
    s_memtime s[84:85]
    s_waitcnt lgkmcnt(0)
    s_load_dword s54, s[56:57], 0 glc
    s_waitcnt lgkmcnt(0)
    s_memtime s[86:87]
    s_waitcnt lgkmcnt(0)
    s_sub_u32 s54, s86, s84
    s_min_u32 s52, s52, s54
    s_memtime s[84:85]
    s_waitcnt lgkmcnt(0)
    s_load_dword s54, s[56:57], 8192 glc
    s_waitcnt lgkmcnt(0)
    s_memtime s[86:87]
    s_waitcnt lgkmcnt(0)
    s_sub_u32 s54, s86, s84
    s_min_u32 s53, s53, s54
    s_cmp_lt_u32 s52, s53
    s_cselect_b32 s54, 1, 2
    v_mov_b32 v5, s54
    ds_write_b32 v10, v5 offset:36
S_62:
    ds_read_b32 v5, v10 offset:0
    ds_read_b64_tr_b16 v[56:57], v76 offset:0
    ds_read_b64_tr_b16 v[58:59], v76 offset:512
    ds_read_b64_tr_b16 v[60:61], v76 offset:4096
    ds_read_b64_tr_b16 v[62:63], v76 offset:4608
    ds_read_b64_tr_b16 v[64:65], v76 offset:8192
    ds_read_b64_tr_b16 v[66:67], v76 offset:8704
    ds_read_b64_tr_b16 v[68:69], v76 offset:12288
    ds_read_b64_tr_b16 v[70:71], v76 offset:12800
    s_waitcnt lgkmcnt(8)
    v_readfirstlane_b32 s15, v5
    s_cmp_ge_u32 s15, 2
    s_cbranch_scc1 OK_64
    s_mov_b32 s14, 2000000
W_63:
    ds_read_b32 v5, v10 offset:0
    s_waitcnt lgkmcnt(0)
    v_readfirstlane_b32 s15, v5
    s_cmp_ge_u32 s15, 2
    s_cbranch_scc1 AG_65
    s_sleep 2
    s_sub_u32 s14, s14, 1
    s_cbranch_scc0 W_63
    s_branch L_fail
AG_65:
    ds_read_b64_tr_b16 v[56:57], v76 offset:0
    ds_read_b64_tr_b16 v[58:59], v76 offset:512
    ds_read_b64_tr_b16 v[60:61], v76 offset:4096
    ds_read_b64_tr_b16 v[62:63], v76 offset:4608
    ds_read_b64_tr_b16 v[64:65], v76 offset:8192
    ds_read_b64_tr_b16 v[66:67], v76 offset:8704
    ds_read_b64_tr_b16 v[68:69], v76 offset:12288
    ds_read_b64_tr_b16 v[70:71], v76 offset:12800
OK_64:
    s_waitcnt lgkmcnt(6)
    v_mfma_f32_16x16x32_bf16 v[72:75], v[56:59], v[40:43], 0
    s_waitcnt lgkmcnt(4)
    v_mfma_f32_16x16x32_bf16 v[72:75], v[60:63], v[44:47], v[72:75]
    s_waitcnt lgkmcnt(2)
    v_mfma_f32_16x16x32_bf16 v[72:75], v[64:67], v[48:51], v[72:75]
    s_waitcnt lgkmcnt(0)
    v_mfma_f32_16x16x32_bf16 v[72:75], v[68:71], v[52:55], v[72:75]
    s_nop 7
    v_and_or_b32 v72, v72, s47, v11
    v_and_or_b32 v73, v73, s47, v11
    v_and_or_b32 v74, v74, s47, v11
    v_and_or_b32 v75, v75, s47, v11
    s_mov_b32 exec_lo, 0x10001
    s_mov_b32 exec_hi, 0x10001
    global_store_dwordx4 v39, v[72:75], s[42:43] sc1
    s_mov_b64 exec, -1
    s_branch L_W_att
L_W_03:
    s_sub_u32 s57, s3, 1
    s_cmp_lt_u32 s57, 2
    s_cbranch_scc0 L_W_main
    s_mov_b32 s13, 1
    s_lshl_b32 s11, s10, 1
    s_add_u32 s11, s11, s57
    s_lshl_b32 s56, s11, 6
    v_lshl_add_u32 v76, v1, 2, s56
    s_and_b32 s56, s11, 3
    s_lshl_b32 s56, s56, 6
    s_lshr_b32 s57, s11, 2
    s_lshl_b32 s57, s57, 8
    s_add_u32 s56, s56, s57
    s_add_u32 s56, s56, 65536
    v_lshlrev_b32 v5, 12, v2
    v_and_b32 v6, 0x2000, v5
    v_add_u32 v5, v5, v6
    v_lshlrev_b32 v6, 2, v1
    v_add3_u32 v74, v5, v6, s56
    v_add_u32 v75, 32768, v74
    s_waitcnt vmcnt(0)
    v_lshlrev_b32 v80, 16, v20
    v_and_b32 v81, s49, v20
    v_lshlrev_b32 v82, 16, v21
    v_and_b32 v83, s49, v21
    v_lshlrev_b32 v84, 16, v22
    v_and_b32 v85, s49, v22
    v_lshlrev_b32 v86, 16, v23
    v_and_b32 v87, s49, v23
    v_add_f32 v72, v80, v81
    v_add_f32 v72, v72, v82
    v_add_f32 v72, v72, v83
    v_add_f32 v72, v72, v84
    v_add_f32 v72, v72, v85
    v_add_f32 v72, v72, v86
    v_add_f32 v72, v72, v87
    s_nop 1
    v_add_f32_dpp v72, v72, v72 row_ror:8 row_mask:0xf bank_mask:0xf
    s_nop 1
    v_add_f32_dpp v72, v72, v72 row_ror:4 row_mask:0xf bank_mask:0xf
    s_nop 1
    v_add_f32_dpp v72, v72, v72 row_ror:2 row_mask:0xf bank_mask:0xf
    s_nop 1
    v_add_f32_dpp v72, v72, v72 row_ror:1 row_mask:0xf bank_mask:0xf
    v_mov_b32 v5, v72
    s_nop 1
    v_permlane16_swap_b32 v72, v5
    v_add_f32 v72, v72, v5
    v_mov_b32 v5, v72
    s_nop 1
    v_permlane32_swap_b32 v72, v5
    v_add_f32 v72, v72, v5
    v_mul_f32 v72, 0x3b000000, v72
    v_sub_f32 v80, v80, v72
    v_sub_f32 v81, v81, v72
    v_sub_f32 v82, v82, v72
    v_sub_f32 v83, v83, v72
    v_sub_f32 v84, v84, v72
    v_sub_f32 v85, v85, v72
    v_sub_f32 v86, v86, v72
    v_sub_f32 v87, v87, v72
    v_mul_f32 v73, v80, v80
    v_fmac_f32 v73, v81, v81
    v_fmac_f32 v73, v82, v82
    v_fmac_f32 v73, v83, v83
    v_fmac_f32 v73, v84, v84
    v_fmac_f32 v73, v85, v85
    v_fmac_f32 v73, v86, v86
    v_fmac_f32 v73, v87, v87
    s_nop 1
    v_add_f32_dpp v73, v73, v73 row_ror:8 row_mask:0xf bank_mask:0xf
    s_nop 1
    v_add_f32_dpp v73, v73, v73 row_ror:4 row_mask:0xf bank_mask:0xf
    s_nop 1
    v_add_f32_dpp v73, v73, v73 row_ror:2 row_mask:0xf bank_mask:0xf
    s_nop 1
    v_add_f32_dpp v73, v73, v73 row_ror:1 row_mask:0xf bank_mask:0xf
    v_mov_b32 v5, v73
    s_nop 1
    v_permlane16_swap_b32 v73, v5
    v_add_f32 v73, v73, v5
    v_mov_b32 v5, v73
    s_nop 1
    v_permlane32_swap_b32 v73, v5
    v_add_f32 v73, v73, v5
    v_mul_f32 v73, 0x3b000000, v73
    v_cvt_pk_bf16_f32 v72, v72, v72
    v_and_b32 v72, s49, v72
    v_cvt_pk_bf16_f32 v73, v73, v73
    v_and_b32 v73, s49, v73
    v_add_f32 v73, 0x3727c5ac, v73
    v_cvt_pk_bf16_f32 v73, v73, v73
    v_and_b32 v73, s49, v73
    v_sqrt_f32 v73, v73
    s_nop 0
    v_cvt_pk_bf16_f32 v73, v73, v73
    v_and_b32 v73, s49, v73
    v_lshlrev_b32 v34, 16, v24
    v_sub_f32 v24, v34, v72
    v_cvt_pk_bf16_f32 v24, v24, v24
    v_and_b32 v24, s49, v24
    v_rcp_f32 v5, v73
    s_nop 0
    v_mul_f32 v6, v24, v5
    v_fma_f32 v7, -v6, v73, v24
    v_fma_f32 v24, v7, v5, v6
    v_cvt_pk_bf16_f32 v24, v24, v24
    v_and_b32 v24, s49, v24
    s_mov_b32 s14, 2000000
W_66:
    ds_read_b32 v5, v10 offset:0
    s_waitcnt lgkmcnt(0)
    v_readfirstlane_b32 s15, v5
    s_cmp_ge_u32 s15, 1
    s_cbranch_scc1 AG_68
    s_sub_u32 s14, s14, 1
    s_cbranch_scc0 W_66
    s_branch L_fail
AG_68:
OK_67:
    ds_read_b64_tr_b16 v[40:41], v25 offset:0
    ds_read_b64_tr_b16 v[42:43], v25 offset:512
    ds_read_b64_tr_b16 v[44:45], v25 offset:4096
    ds_read_b64_tr_b16 v[46:47], v25 offset:4608
    ds_read_b64_tr_b16 v[48:49], v25 offset:8192
    ds_read_b64_tr_b16 v[50:51], v25 offset:8704
    ds_read_b64_tr_b16 v[52:53], v25 offset:12288
    ds_read_b64_tr_b16 v[54:55], v25 offset:12800
    s_waitcnt lgkmcnt(4)
    ds_read_b64_tr_b16 v[56:57], v25 offset:16384
    ds_read_b64_tr_b16 v[58:59], v25 offset:16896
    ds_read_b64_tr_b16 v[60:61], v25 offset:20480
    ds_read_b64_tr_b16 v[62:63], v25 offset:20992
    ds_read_b64_tr_b16 v[64:65], v25 offset:24576
    ds_read_b64_tr_b16 v[66:67], v25 offset:25088
    ds_read_b64_tr_b16 v[68:69], v25 offset:28672
    ds_read_b64_tr_b16 v[70:71], v25 offset:29184
    ds_read_b32 v5, v10 offset:36
    s_waitcnt lgkmcnt(0)
    v_readfirstlane_b32 s56, v5
    s_cmp_eq_u32 s56, 1
    s_cselect_b32 s51, 0, s51
    s_cmp_eq_u32 s56, 2
    s_cselect_b32 s51, 0x2000, s51
    v_add_u32 v74, s51, v74
    v_add_u32 v75, s51, v75
    s_mov_b32 s14, 2000000
P_69:
    global_load_dword v88, v74, s[42:43] sc1
    global_load_dword v89, v74, s[42:43] offset:2048 sc1
    global_load_dword v90, v75, s[42:43] sc1
    global_load_dword v91, v75, s[42:43] offset:2048 sc1
    ds_read_b32 v13, v10 offset:52
PW_71:
    s_waitcnt vmcnt(0)
    v_xor_b32 v80, s7, v88
    v_xor_b32 v81, s7, v89
    v_xor_b32 v82, s7, v90
    v_xor_b32 v83, s7, v91
    v_or3_b32 v9, v80, v81, v82
    v_or_b32 v9, v9, v83
    v_and_b32 v9, 0x3f, v9
    v_cmp_ne_u32 vcc, 0, v9
    s_cbranch_vccz OK_70
    s_sub_u32 s14, s14, 1
    s_cbranch_scc0 P_69
    s_branch L_fail
OK_70:
    v_add_f32 v80, v80, v82
    v_add_f32 v81, v81, v83
    s_nop 1
    v_permlane32_swap_b32 v80, v81
    v_add_f32 v80, v80, v81
    v_mov_b32 v81, v80
    s_nop 1
    v_permlane16_swap_b32 v80, v81
    v_add_f32 v80, v80, v81
    v_cvt_pk_bf16_f32 v80, v80, v80
    v_and_b32 v80, s49, v80
    v_mov_b32 v81, v80
    s_nop 1
    v_permlane32_swap_b32 v80, v81
    v_add_f32 v81, 1.0, v81
    v_cvt_pk_bf16_f32 v81, v81, v81
    v_and_b32 v81, s49, v81
    v_mul_f32 v81, v24, v81
    v_cvt_pk_bf16_f32 v81, v81, v81
    v_and_b32 v81, s49, v81
    v_add_f32 v81, v81, v80
    v_cvt_pk_bf16_f32 v81, v81, v81
    v_and_b32 v81, s49, v81
    v_or_b32 v81, s8, v81
    s_waitcnt lgkmcnt(0)
    v_readfirstlane_b32 s46, v13
    s_mov_b32 exec_lo, 0xffff
    s_mov_b32 exec_hi, 0x0
    s_cmp_eq_u32 s46, 1
    s_cbranch_scc0 SL_72
    global_store_dword v76, v81, s[44:45] offset:0
BK_73:
    s_mov_b64 exec, -1
    ds_write_b32 v10, v14 offset:8
    s_branch L_W_q
L_W_main:
    global_load_dword v17, v26, s[44:45] sc1
    s_mov_b32 s14, 2000000
W_74:
    ds_read_b32 v5, v10 offset:0
    s_waitcnt lgkmcnt(0)
    v_readfirstlane_b32 s15, v5
    s_cmp_ge_u32 s15, 1
    s_cbranch_scc1 AG_76
    s_sub_u32 s14, s14, 1
    s_cbranch_scc0 W_74
    s_branch L_fail
AG_76:
OK_75:
    ds_read_b64_tr_b16 v[40:41], v25 offset:0
    ds_read_b64_tr_b16 v[42:43], v25 offset:512
    ds_read_b64_tr_b16 v[44:45], v25 offset:4096
    ds_read_b64_tr_b16 v[46:47], v25 offset:4608
    ds_read_b64_tr_b16 v[48:49], v25 offset:8192
    ds_read_b64_tr_b16 v[50:51], v25 offset:8704
    ds_read_b64_tr_b16 v[52:53], v25 offset:12288
    ds_read_b64_tr_b16 v[54:55], v25 offset:12800
    s_waitcnt lgkmcnt(4)
    ds_read_b64_tr_b16 v[56:57], v25 offset:16384
    ds_read_b64_tr_b16 v[58:59], v25 offset:16896
    ds_read_b64_tr_b16 v[60:61], v25 offset:20480
    ds_read_b64_tr_b16 v[62:63], v25 offset:20992
    ds_read_b64_tr_b16 v[64:65], v25 offset:24576
    ds_read_b64_tr_b16 v[66:67], v25 offset:25088
    ds_read_b64_tr_b16 v[68:69], v25 offset:28672
    ds_read_b64_tr_b16 v[70:71], v25 offset:29184
    s_mov_b32 s14, 2000000
W_77:
    ds_read_b32 v5, v10 offset:8
    s_waitcnt lgkmcnt(0)
    v_readfirstlane_b32 s15, v5
    s_cmp_ge_u32 s15, 1
    s_cbranch_scc1 AG_79
    s_sleep 1
    s_sub_u32 s14, s14, 1
    s_cbranch_scc0 W_77
    s_branch L_fail
AG_79:
OK_78:
L_W_q:
    s_mov_b32 s14, 2000000
P_80:
    global_load_dwordx4 v[108:111], v26, s[44:45] offset:0 sc1
    ds_read_b32 v13, v10 offset:52
PW_82:
    s_waitcnt vmcnt(0)
    v_xor_b32 v112, s8, v108
    v_xor_b32 v113, s8, v109
    v_xor_b32 v114, s8, v110
    v_xor_b32 v115, s8, v111
    v_or3_b32 v9, v112, v113, v114
    v_or_b32 v9, v9, v115
    v_and_b32 v9, 0xffff, v9
    v_cmp_ne_u32 vcc, 0, v9
    s_cbranch_vccz OK_81
    s_sub_u32 s14, s14, 1
    s_cbranch_scc0 P_80
    s_branch L_fail
OK_81:
    v_perm_b32 v116, v113, v112, s48
    v_perm_b32 v117, v115, v114, s48
    ds_write_b64 v27, v[116:117]
    ds_read_b128 v[72:75], v28 offset:0
    ds_read_b128 v[76:79], v28 offset:64
    ds_read_b128 v[80:83], v28 offset:128
    ds_read_b128 v[84:87], v28 offset:192
    ds_read_b128 v[88:91], v28 offset:256
    ds_read_b128 v[92:95], v28 offset:320
    ds_read_b128 v[96:99], v28 offset:384
    ds_read_b128 v[100:103], v28 offset:448
    s_waitcnt lgkmcnt(7)
    v_readfirstlane_b32 s46, v13
    v_mfma_f32_16x16x32_bf16 v[104:107], v[40:43], v[72:75], 0
    s_waitcnt lgkmcnt(6)
    v_mfma_f32_16x16x32_bf16 v[104:107], v[44:47], v[76:79], v[104:107]
    s_waitcnt lgkmcnt(5)
    v_mfma_f32_16x16x32_bf16 v[104:107], v[48:51], v[80:83], v[104:107]
    s_waitcnt lgkmcnt(4)
    v_mfma_f32_16x16x32_bf16 v[104:107], v[52:55], v[84:87], v[104:107]
    s_waitcnt lgkmcnt(3)
    v_mfma_f32_16x16x32_bf16 v[104:107], v[56:59], v[88:91], v[104:107]
    s_waitcnt lgkmcnt(2)
    v_mfma_f32_16x16x32_bf16 v[104:107], v[60:63], v[92:95], v[104:107]
    s_waitcnt lgkmcnt(1)
    v_mfma_f32_16x16x32_bf16 v[104:107], v[64:67], v[96:99], v[104:107]
    s_waitcnt lgkmcnt(0)
    v_mfma_f32_16x16x32_bf16 v[104:107], v[68:71], v[100:103], v[104:107]
    s_nop 7
    v_and_or_b32 v104, v104, s47, v11
    v_and_or_b32 v105, v105, s47, v11
    v_and_or_b32 v106, v106, s47, v11
    v_and_or_b32 v107, v107, s47, v11
    s_mov_b32 exec_lo, 0x10001
    s_mov_b32 exec_hi, 0x10001
    s_cmp_eq_u32 s46, 1
    s_cbranch_scc0 SL_83
    global_store_dwordx4 v29, v[104:107], s[44:45]
BK_84:
    s_mov_b64 exec, -1
    ds_write_b32 v10, v14 offset:12
    s_waitcnt vmcnt(0)
    s_cmp_eq_u32 s13, 1
    s_cbranch_scc0 L_W_att
    s_lshl_b32 s57, s11, 5
    v_lshl_add_u32 v63, v1, 1, s57
    v_lshrrev_b32 v7, 5, v0
    v_lshl_add_u32 v60, v4, 2, v7
    v_and_b32 v7, 1, v2
    v_lshl_add_u32 v60, v7, 1, v60
    s_lshl_b32 s56, s11, 10
    s_and_b32 s57, s56, 0xffffe000
    s_add_u32 s56, s56, s57
    s_lshl_b32 s57, s4, 7
    s_add_u32 s57, s57, s56
    v_lshl_add_u32 v60, v60, 2, s57
    v_lshlrev_b32 v61, 7, v2
    v_lshl_add_u32 v61, v1, 2, v61
    v_add_u32 v61, s56, v61
    v_and_b32 v7, 1, v3
    v_lshl_add_u32 v60, v7, 13, v60
    v_add_u32 v60, 131072, v60
    v_add_u32 v76, 65536, v60
    s_lshl_b32 s56, s11, 6
    s_add_u32 s57, s56, 6144
    v_lshl_add_u32 v62, v1, 2, s57
    v_not_b32 v5, v11
    s_mov_b32 exec_lo, 0xff00ff
    s_mov_b32 exec_hi, 0xff00ff
    global_store_dword v60, v5, s[42:43] sc1
    global_store_dword v76, v5, s[42:43] sc1
    s_mov_b64 exec, -1
    v_lshrrev_b32 v7, 2, v0
    v_lshlrev_b32 v64, 11, v7
    v_lshl_add_u32 v64, v4, 4, v64
    s_lshl_b32 s56, s11, 6
    s_add_u32 s57, s56, 65536
    v_add_u32 v64, s57, v64
    s_add_u32 s57, s56, 25600
    v_lshl_add_u32 v65, v1, 2, s57
    global_load_dword v17, v64, s[44:45] sc1
    global_load_dword v17, v65, s[44:45] sc1
    global_load_dword v17, v65, s[44:45] offset:2048 sc1
    s_mov_b32 s14, 2000000
W_85:
    ds_read_b32 v5, v10 offset:20
    s_waitcnt lgkmcnt(0)
    v_readfirstlane_b32 s15, v5
    s_cmp_ge_u32 s15, 1
    s_cbranch_scc1 AG_87
    s_sleep 1
    s_sub_u32 s14, s14, 1
    s_cbranch_scc0 W_85
    s_branch L_fail
AG_87:
OK_86:
    ds_read_b32 v5, v10 offset:36
    s_waitcnt lgkmcnt(0)
    v_readfirstlane_b32 s56, v5
    s_cmp_eq_u32 s56, 1
    s_cselect_b32 s51, 0, s51
    s_cmp_eq_u32 s56, 2
    s_cselect_b32 s51, 0x2000, s51
    s_add_u32 s57, s51, 131072
    v_add_u32 v61, s57, v61
    v_add_u32 v77, 65536, v61
L_W_att:
    s_mov_b32 s14, 2000000
W_88:
    ds_read_b32 v5, v10 offset:0
    s_waitcnt lgkmcnt(0)
    v_readfirstlane_b32 s15, v5
    s_cmp_ge_u32 s15, 3
    s_cbranch_scc1 AG_90
    s_sleep 1
    s_sub_u32 s14, s14, 1
    s_cbranch_scc0 W_88
    s_branch L_fail
AG_90:
OK_89:
    v_xor_b32 v5, 0, v30
    ds_read_b64_tr_b16 v[80:81], v5
    ds_read_b64_tr_b16 v[82:83], v5 offset:4096
    v_xor_b32 v5, 32, v30
    ds_read_b64_tr_b16 v[84:85], v5
    ds_read_b64_tr_b16 v[86:87], v5 offset:4096
    v_xor_b32 v5, 64, v30
    ds_read_b64_tr_b16 v[88:89], v5
    ds_read_b64_tr_b16 v[90:91], v5 offset:4096
    v_xor_b32 v5, 96, v30
    ds_read_b64_tr_b16 v[92:93], v5
    ds_read_b64_tr_b16 v[94:95], v5 offset:4096
    ds_read_b32 v13, v10 offset:52
    s_waitcnt lgkmcnt(0)
    v_readfirstlane_b32 s46, v13
    s_barrier
    ds_read_b128 v[96:99], v32
    s_waitcnt lgkmcnt(0)
    v_and_b32 v100, v35, v96
    v_and_b32 v101, v35, v97
    v_and_b32 v102, v35, v98
    v_and_b32 v103, v35, v99
    s_nop 1
    v_mfma_f32_16x16x32_bf16 v[108:111], v[80:83], v[100:103], 0
    v_and_b32 v104, v36, v96
    v_and_b32 v105, v36, v97
    v_and_b32 v106, v36, v98
    v_and_b32 v107, v36, v99
    s_nop 1
    v_mfma_f32_16x16x32_bf16 v[108:111], v[84:87], v[104:107], v[108:111]
    v_and_b32 v100, v37, v96
    v_and_b32 v101, v37, v97
    v_and_b32 v102, v37, v98
    v_and_b32 v103, v37, v99
    s_nop 1
    v_mfma_f32_16x16x32_bf16 v[108:111], v[88:91], v[100:103], v[108:111]
    v_and_b32 v104, v38, v96
    v_and_b32 v105, v38, v97
    v_and_b32 v106, v38, v98
    v_and_b32 v107, v38, v99
    s_nop 1
    v_mfma_f32_16x16x32_bf16 v[108:111], v[92:95], v[104:107], v[108:111]
    s_nop 7
    v_and_or_b32 v108, v108, s47, v11
    v_and_or_b32 v109, v109, s47, v11
    v_and_or_b32 v110, v110, s47, v11
    v_and_or_b32 v111, v111, s47, v11
    s_mov_b32 exec_lo, 0xf000f
    s_mov_b32 exec_hi, 0xf000f
    s_cmp_eq_u32 s46, 1
    s_cbranch_scc0 SL_91
    global_store_dwordx4 v31, v[108:111], s[44:45]
BK_92:
    s_mov_b64 exec, -1
    s_cmp_eq_u32 s13, 1
    s_cbranch_scc0 L_W_end
    s_mov_b32 s14, 2000000
    global_load_dwordx4 v[40:43], v64, s[44:45] sc1
    s_sleep 2
PP_93:
    global_load_dwordx4 v[44:47], v64, s[44:45] sc1
    s_waitcnt vmcnt(1)
    v_xor_b32 v56, s7, v40
    v_xor_b32 v57, s7, v41
    v_xor_b32 v58, s7, v42
    v_xor_b32 v59, s7, v43
    v_or3_b32 v9, v56, v57, v58
    v_or_b32 v9, v9, v59
    v_and_b32 v9, 0x3f, v9
    v_cmp_ne_u32 vcc, 0, v9
    s_cbranch_vccz OK_94
    global_load_dwordx4 v[40:43], v64, s[44:45] sc1
    s_waitcnt vmcnt(1)
    v_xor_b32 v56, s7, v44
    v_xor_b32 v57, s7, v45
    v_xor_b32 v58, s7, v46
    v_xor_b32 v59, s7, v47
    v_or3_b32 v9, v56, v57, v58
    v_or_b32 v9, v9, v59
    v_and_b32 v9, 0x3f, v9
    v_cmp_ne_u32 vcc, 0, v9
    s_cbranch_vccz OK_94
    s_sub_u32 s14, s14, 1
    s_cbranch_scc0 PP_93
    s_branch L_fail
OK_94:
    global_load_dword v72, v65, s[44:45] sc1
    global_load_dword v73, v65, s[44:45] offset:2048 sc1
    v_permlane32_swap_b32 v56, v57
    v_permlane32_swap_b32 v58, v59
    v_add_f32 v56, v56, v57
    v_add_f32 v58, v58, v59
    s_nop 1
    v_permlane16_swap_b32 v56, v58
    v_add_f32 v56, v56, v58
    s_nop 1
    v_add_f32_dpp v56, v56, v56 row_ror:4 row_mask:0xf bank_mask:0xf
    s_nop 1
    v_add_f32_dpp v56, v56, v56 row_ror:8 row_mask:0xf bank_mask:0xf
    v_and_or_b32 v56, v56, s47, v11
    s_mov_b32 exec_lo, 0xff00ff
    s_mov_b32 exec_hi, 0xff00ff
    global_store_dword v60, v56, s[42:43] sc1
    s_mov_b64 exec, -1
    s_sleep 6
    s_mov_b32 s14, 2000000
P_95:
    global_atomic_add v40, v61, v18, s[42:43] sc0 sc1
    global_atomic_add v41, v61, v18, s[42:43] offset:512 sc0 sc1
PW_97:
    s_waitcnt vmcnt(0)
    v_xor_b32 v56, s7, v40
    v_xor_b32 v57, s7, v41
    v_or_b32 v9, v56, v57
    v_and_b32 v9, 0x3f, v9
    v_cmp_ne_u32 vcc, 0, v9
    s_cbranch_vccz OK_96
    s_sub_u32 s14, s14, 1
    s_cbranch_scc0 P_95
    s_branch L_fail
OK_96:
    v_add_f32 v56, v56, v57
    v_mov_b32 v5, v56
    s_nop 1
    v_permlane16_swap_b32 v56, v5
    v_add_f32 v56, v56, v5
    v_mov_b32 v5, v56
    s_nop 1
    v_permlane32_swap_b32 v56, v5
    v_add_f32 v56, v56, v5
    v_cvt_pk_bf16_f32 v56, v56, v56
    v_and_b32 v56, s49, v56
    v_xor_b32 v66, s8, v72
    v_xor_b32 v67, s8, v73
    v_or_b32 v9, v66, v67
    v_and_b32 v9, 0xffff, v9
    v_cmp_ne_u32 vcc, 0, v9
    s_cbranch_vccz OK_99
    s_mov_b32 s14, 2000000
P_100:
    global_load_dword v72, v65, s[44:45] sc1
    global_load_dword v73, v65, s[44:45] offset:2048 sc1
PW_102:
    s_waitcnt vmcnt(0)
    v_xor_b32 v66, s8, v72
    v_xor_b32 v67, s8, v73
    v_or_b32 v9, v66, v67
    v_and_b32 v9, 0xffff, v9
    v_cmp_ne_u32 vcc, 0, v9
    s_cbranch_vccz OK_101
    s_sub_u32 s14, s14, 1
    s_cbranch_scc0 P_100
    s_branch L_fail
OK_101:
OK_99:
    v_mul_f32 v56, v66, v56
    v_cvt_pk_bf16_f32 v56, v56, v56
    v_and_b32 v56, s49, v56
    v_add_f32 v34, v34, v56
    v_cvt_pk_bf16_f32 v34, v34, v34
    v_and_b32 v34, s49, v34
    v_or_b32 v5, s8, v34
    s_mov_b32 exec_lo, 0xffff
    s_mov_b32 exec_hi, 0x0
    s_cmp_eq_u32 s46, 1
    s_cbranch_scc0 SL_103
    global_store_dword v62, v5, s[44:45]
BK_104:
    s_or_b32 s56, s11, s4
    s_cbranch_scc1 S_105
    s_mov_b64 exec, 1
    v_mov_b32 v7, 0
    v_mov_b32 v6, s6
    global_store_dword v7, v6, s[42:43]
S_105:
    s_mov_b64 exec, -1
    s_mov_b32 s14, 2000000
    global_load_dwordx4 v[40:43], v64, s[44:45] sc1
    s_sleep 2
PP_106:
    global_load_dwordx4 v[44:47], v64, s[44:45] sc1
    s_waitcnt vmcnt(1)
    v_xor_b32 v56, s9, v40
    v_xor_b32 v57, s9, v41
    v_xor_b32 v58, s9, v42
    v_xor_b32 v59, s9, v43
    v_or3_b32 v9, v56, v57, v58
    v_or_b32 v9, v9, v59
    v_and_b32 v9, 0x3f, v9
    v_cmp_ne_u32 vcc, 0, v9
    s_cbranch_vccz OK_107
    global_load_dwordx4 v[40:43], v64, s[44:45] sc1
    s_waitcnt vmcnt(1)
    v_xor_b32 v56, s9, v44
    v_xor_b32 v57, s9, v45
    v_xor_b32 v58, s9, v46
    v_xor_b32 v59, s9, v47
    v_or3_b32 v9, v56, v57, v58
    v_or_b32 v9, v9, v59
    v_and_b32 v9, 0x3f, v9
    v_cmp_ne_u32 vcc, 0, v9
    s_cbranch_vccz OK_107
    s_sub_u32 s14, s14, 1
    s_cbranch_scc0 PP_106
    s_branch L_fail
OK_107:
    v_permlane32_swap_b32 v56, v57
    v_permlane32_swap_b32 v58, v59
    v_add_f32 v56, v56, v57
    v_add_f32 v58, v58, v59
    s_nop 1
    v_permlane16_swap_b32 v56, v58
    v_add_f32 v56, v56, v58
    s_nop 1
    v_add_f32_dpp v56, v56, v56 row_ror:4 row_mask:0xf bank_mask:0xf
    s_nop 1
    v_add_f32_dpp v56, v56, v56 row_ror:8 row_mask:0xf bank_mask:0xf
    v_and_or_b32 v56, v56, s47, v11
    s_mov_b32 exec_lo, 0xff00ff
    s_mov_b32 exec_hi, 0xff00ff
    global_store_dword v76, v56, s[42:43] sc1
    s_mov_b64 exec, -1
    s_and_b32 s56, s11, 7
    s_cmp_eq_u32 s56, s4
    s_cbranch_scc0 L_W_end
    s_mov_b32 s14, 2000000
    global_atomic_add v40, v77, v18, s[42:43] sc0 sc1
    global_atomic_add v41, v77, v18, s[42:43] offset:512 sc0 sc1
    s_sleep 4
    global_atomic_add v44, v77, v18, s[42:43] sc0 sc1
    global_atomic_add v45, v77, v18, s[42:43] offset:512 sc0 sc1
    s_sleep 4
PP_108:
    global_atomic_add v48, v77, v18, s[42:43] sc0 sc1
    global_atomic_add v49, v77, v18, s[42:43] offset:512 sc0 sc1
    s_waitcnt vmcnt(4)
    v_xor_b32 v56, s7, v40
    v_xor_b32 v57, s7, v41
    v_or_b32 v9, v56, v57
    v_and_b32 v9, 0x3f, v9
    v_cmp_ne_u32 vcc, 0, v9
    s_cbranch_vccz OK_109
    global_atomic_add v40, v77, v18, s[42:43] sc0 sc1
    global_atomic_add v41, v77, v18, s[42:43] offset:512 sc0 sc1
    s_waitcnt vmcnt(4)
    v_xor_b32 v56, s7, v44
    v_xor_b32 v57, s7, v45
    v_or_b32 v9, v56, v57
    v_and_b32 v9, 0x3f, v9
    v_cmp_ne_u32 vcc, 0, v9
    s_cbranch_vccz OK_109
    global_atomic_add v44, v77, v18, s[42:43] sc0 sc1
    global_atomic_add v45, v77, v18, s[42:43] offset:512 sc0 sc1
    s_waitcnt vmcnt(4)
    v_xor_b32 v56, s7, v48
    v_xor_b32 v57, s7, v49
    v_or_b32 v9, v56, v57
    v_and_b32 v9, 0x3f, v9
    v_cmp_ne_u32 vcc, 0, v9
    s_cbranch_vccz OK_109
    s_sub_u32 s14, s14, 1
    s_cbranch_scc0 PP_108
    s_branch L_fail
OK_109:
    v_add_f32 v56, v56, v57
    v_mov_b32 v5, v56
    s_nop 1
    v_permlane16_swap_b32 v56, v5
    v_add_f32 v56, v56, v5
    v_mov_b32 v5, v56
    s_nop 1
    v_permlane32_swap_b32 v56, v5
    v_add_f32 v56, v56, v5
    v_cvt_pk_bf16_f32 v56, v56, v56
    v_and_b32 v56, s49, v56
    v_mul_f32 v56, v67, v56
    v_cvt_pk_bf16_f32 v56, v56, v56
    v_and_b32 v56, s49, v56
    v_add_f32 v34, v34, v56
    v_cvt_pk_bf16_f32 v34, v34, v34
    s_mov_b32 exec_lo, 0xffff
    s_mov_b32 exec_hi, 0x0
    global_store_short v63, v34, s[38:39]
L_W_end2:
    s_mov_b64 exec, -1
L_W_end:
    s_endpgm
L_W9:
    v_lshrrev_b32 v5, 3, v0
    v_and_b32 v6, 7, v0
    s_lshr_b32 s57, s10, 2
    s_lshl_b32 s56, s57, 4
    s_add_u32 s56, s56, 8192
    v_lshl_add_u32 v25, v5, 6, s56
    s_lshl_b32 s56, s57, 9
    s_and_b32 s57, s10, 3
    s_lshl_b32 s57, s57, 7
    s_add_u32 s56, s56, s57
    s_add_u32 s56, s56, 32768
    v_lshlrev_b32 v26, 11, v5
    v_lshl_add_u32 v26, v6, 4, v26
    v_add_u32 v26, s56, v26
    v_add_u32 v27, 16384, v26
    v_lshrrev_b32 v5, 5, v0
    v_lshl_add_u32 v28, v6, 2, v5
    v_and_b32 v5, 1, v2
    v_lshl_add_u32 v28, v5, 1, v28
    v_lshlrev_b32 v28, 1, v28
    v_add_u32 v28, 159744, v28
    s_barrier
    s_waitcnt lgkmcnt(0)
    s_add_u32 s6, s6, 1
    s_and_b32 s7, s6, 0x3f
    s_and_b32 s8, s6, 0xffff
    s_xor_b32 s9, s7, 0x20
    v_mov_b32 v11, s7
    v_mov_b32 v12, s9
    s_mul_i32 s52, s52, 0x01010101
    v_and_b32 v6, 7, v0
    s_lshl_b32 s56, s4, 5
    v_lshl_add_u32 v6, v6, 2, s56
    s_mov_b32 s14, 40
PP_110:
    global_load_dword v5, v6, s[40:41] sc1
    s_waitcnt vmcnt(0)
    v_cmp_ne_u32 vcc, s52, v5
    s_cbranch_vccz PP_110_ok
    s_sub_u32 s14, s14, 1
    s_cbranch_scc0 PP_110
    s_branch PD_111
PP_110_ok:
    ds_write_b32 v10, v14 offset:52
PD_111:
    s_mov_b32 s14, 2000000
W_112:
    ds_read_b32 v5, v10 offset:12
    s_waitcnt lgkmcnt(0)
    v_readfirstlane_b32 s15, v5
    s_cmp_ge_u32 s15, 1
    s_cbranch_scc1 AG_114
    s_sleep 2
    s_sub_u32 s14, s14, 1
    s_cbranch_scc0 W_112
    s_branch L_fail
AG_114:
OK_113:
    v_lshlrev_b32 v8, 3, v1
    v_add_u32 v8, 10240, v8
    s_mov_b32 s14, 2000000
P_115:
    global_load_dword v5, v8, s[44:45] sc1
    s_waitcnt vmcnt(0)
    v_cmp_ne_u32 vcc, s6, v5
    s_cbranch_vccz OK_116
    s_sub_u32 s14, s14, 1
    s_cbranch_scc0 P_115
    s_branch L_fail
OK_116:
    ds_write_b32 v10, v14 offset:40
    global_load_dword v17, v26, s[44:45] sc1
    global_load_dword v17, v27, s[44:45] sc1
    global_load_dword v17, v25, s[44:45] sc1
    global_load_dword v17, v25, s[44:45] offset:512 sc1
    s_mov_b32 s14, 2000000
W_117:
    ds_read_b32 v5, v10 offset:20
    s_waitcnt lgkmcnt(0)
    v_readfirstlane_b32 s15, v5
    s_cmp_ge_u32 s15, 1
    s_cbranch_scc1 AG_119
    s_sleep 1
    s_sub_u32 s14, s14, 1
    s_cbranch_scc0 W_117
    s_branch L_fail
AG_119:
OK_118:
    s_mov_b32 s14, 2000000
P_120:
    global_load_dwordx4 v[32:35], v25, s[44:45] sc1
    global_load_dwordx4 v[36:39], v25, s[44:45] offset:512 sc1
PW_122:
    s_waitcnt vmcnt(0)
    v_xor_b32 v40, s7, v32
    v_xor_b32 v41, s7, v33
    v_xor_b32 v42, s7, v36
    v_xor_b32 v43, s7, v37
    v_or3_b32 v9, v40, v41, v42
    v_or_b32 v9, v9, v43
    v_and_b32 v9, 0x3f, v9
    v_xor_b32 v34, s6, v34
    v_or_b32 v9, v9, v34
    v_xor_b32 v35, s6, v35
    v_or_b32 v9, v9, v35
    v_xor_b32 v38, s6, v38
    v_or_b32 v9, v9, v38
    v_xor_b32 v39, s6, v39
    v_or_b32 v9, v9, v39
    v_cmp_ne_u32 vcc, 0, v9
    s_cbranch_vccz OK_121
    s_sub_u32 s14, s14, 1
    s_cbranch_scc0 P_120
    s_branch L_fail
OK_121:
    v_max_f32 v5, v40, v42
    s_nop 1
    v_max_f32_dpp v5, v5, v5 row_ror:8 row_mask:0xf bank_mask:0xf
    v_mov_b32 v6, v5
    s_nop 1
    v_permlane16_swap_b32 v5, v6
    v_max_f32 v5, v5, v6
    v_mov_b32 v6, v5
    s_nop 1
    v_permlane32_swap_b32 v5, v6
    v_max_f32 v5, v5, v6
    v_sub_f32 v68, v40, v5
    v_sub_f32 v69, v42, v5
    v_mul_f32 v68, s50, v68
    v_mul_f32 v69, s50, v69
    v_exp_f32 v68, v68
    v_exp_f32 v69, v69
    v_mul_f32 v5, v68, v41
    v_fmac_f32 v5, v69, v43
    s_nop 1
    v_add_f32_dpp v5, v5, v5 row_ror:8 row_mask:0xf bank_mask:0xf
    v_mov_b32 v6, v5
    s_nop 1
    v_permlane16_swap_b32 v5, v6
    v_add_f32 v5, v5, v6
    v_mov_b32 v6, v5
    s_nop 1
    v_permlane32_swap_b32 v5, v6
    v_add_f32 v5, v5, v6
    v_rcp_f32 v5, v5
    s_nop 0
    v_mul_f32 v68, v68, v5
    v_mul_f32 v69, v69, v5
    s_mov_b32 s14, 2000000
    global_load_dwordx4 v[44:47], v26, s[44:45] sc1
    global_load_dwordx4 v[48:51], v27, s[44:45] sc1
    s_sleep 2
PP_123:
    global_load_dwordx4 v[52:55], v26, s[44:45] sc1
    global_load_dwordx4 v[56:59], v27, s[44:45] sc1
    s_waitcnt vmcnt(2)
    v_xor_b32 v60, s7, v44
    v_xor_b32 v61, s7, v45
    v_xor_b32 v62, s7, v46
    v_xor_b32 v63, s7, v47
    v_xor_b32 v64, s7, v48
    v_xor_b32 v65, s7, v49
    v_xor_b32 v66, s7, v50
    v_xor_b32 v67, s7, v51
    v_or3_b32 v9, v60, v61, v62
    v_or3_b32 v9, v9, v63, v64
    v_or3_b32 v9, v9, v65, v66
    v_or_b32 v9, v9, v67
    v_and_b32 v9, 0x3f, v9
    v_cmp_ne_u32 vcc, 0, v9
    s_cbranch_vccz OK_124
    global_load_dwordx4 v[44:47], v26, s[44:45] sc1
    global_load_dwordx4 v[48:51], v27, s[44:45] sc1
    s_waitcnt vmcnt(2)
    v_xor_b32 v60, s7, v52
    v_xor_b32 v61, s7, v53
    v_xor_b32 v62, s7, v54
    v_xor_b32 v63, s7, v55
    v_xor_b32 v64, s7, v56
    v_xor_b32 v65, s7, v57
    v_xor_b32 v66, s7, v58
    v_xor_b32 v67, s7, v59
    v_or3_b32 v9, v60, v61, v62
    v_or3_b32 v9, v9, v63, v64
    v_or3_b32 v9, v9, v65, v66
    v_or_b32 v9, v9, v67
    v_and_b32 v9, 0x3f, v9
    v_cmp_ne_u32 vcc, 0, v9
    s_cbranch_vccz OK_124
    s_sub_u32 s14, s14, 1
    s_cbranch_scc0 PP_123
    s_branch L_fail
OK_124:
    v_mul_f32 v60, v68, v60
    v_mul_f32 v61, v68, v61
    v_mul_f32 v62, v68, v62
    v_mul_f32 v63, v68, v63
    v_fmac_f32 v60, v69, v64
    v_fmac_f32 v61, v69, v65
    v_fmac_f32 v62, v69, v66
    v_fmac_f32 v63, v69, v67
    v_permlane32_swap_b32 v60, v61
    s_nop 0
    v_permlane32_swap_b32 v62, v63
    v_add_f32 v60, v60, v61
    v_add_f32 v62, v62, v63
    s_nop 1
    v_permlane16_swap_b32 v60, v62
    v_add_f32 v60, v60, v62
    s_nop 1
    v_add_f32_dpp v60, v60, v60 row_ror:8 row_mask:0xf bank_mask:0xf
    v_cvt_pk_bf16_f32 v5, v60, v60
    ds_write_b16 v28, v5
    s_waitcnt lgkmcnt(0)
    s_barrier
    s_endpgm
L_loader:
    v_mov_b32 v5, 160000
    v_mov_b32 v8, 1
    v_lshlrev_b32 v4, 4, v0
    s_cmp_ge_u32 s5, 16
    s_cbranch_scc1 L_loaderW
    s_load_dword s6, s[42:43], 0
    v_lshrrev_b32 v2, 4, v0
    v_and_b32 v3, 15, v0
    v_add_u32 v7, 0, v2
    v_xor_b32 v7, v7, v3
    v_lshlrev_b32 v7, 4, v7
    v_lshl_add_u32 v9, v2, 8, v7
    v_add_u32 v7, 4, v2
    v_xor_b32 v7, v7, v3
    v_lshlrev_b32 v7, 4, v7
    v_lshl_add_u32 v10, v2, 8, v7
    v_add_u32 v7, 8, v2
    v_xor_b32 v7, v7, v3
    v_lshlrev_b32 v7, 4, v7
    v_lshl_add_u32 v11, v2, 8, v7
    v_add_u32 v7, 12, v2
    v_xor_b32 v7, v7, v3
    v_lshlrev_b32 v7, 4, v7
    v_lshl_add_u32 v12, v2, 8, v7
    v_add_u32 v7, 0, v2
    v_lshlrev_b32 v7, 1, v7
    v_xor_b32 v7, v7, v3
    v_lshlrev_b32 v7, 4, v7
    v_lshl_add_u32 v13, v2, 8, v7
    v_add_u32 v7, 4, v2
    v_lshlrev_b32 v7, 1, v7
    v_xor_b32 v7, v7, v3
    v_lshlrev_b32 v7, 4, v7
    v_lshl_add_u32 v14, v2, 8, v7
    s_lshl_b32 s56, s4, 22
    s_lshl_b32 s57, s10, 12
    s_add_u32 s56, s56, s57
    s_add_u32 s56, s56, 0x300000
    s_add_u32 s62, s18, s56
    s_addc_u32 s63, s19, 0
    s_add_u32 s60, s20, s56
    s_addc_u32 s61, s21, 0
    s_mov_b32 s55, 69632
    s_mov_b32 m0, 0
    s_nop 0
    global_load_lds_dwordx4 v9, s[62:63] offset:0 nt
    global_load_lds_dwordx4 v10, s[62:63] offset:1024 nt
    global_load_lds_dwordx4 v11, s[62:63] offset:2048 nt
    global_load_lds_dwordx4 v12, s[62:63] offset:3072 nt
    s_barrier
    s_waitcnt vmcnt(4)
    v_mov_b32 v6, 1
    ds_write_b32 v5, v6
    s_mov_b32 s14, 2000000
W_125:
    ds_read_b32 v2, v5 offset:44
    s_waitcnt lgkmcnt(0)
    v_readfirstlane_b32 s15, v2
    s_cmp_ge_u32 s15, 4
    s_cbranch_scc1 AG_127
    s_sub_u32 s14, s14, 1
    s_cbranch_scc0 W_125
    s_branch L_fail
AG_127:
OK_126:
    s_add_u32 s62, s62, 65536
    s_addc_u32 s63, s63, 0
    s_add_u32 m0, m0, 4096
    s_nop 0
    global_load_lds_dwordx4 v9, s[62:63] offset:0 nt
    global_load_lds_dwordx4 v10, s[62:63] offset:1024 nt
    global_load_lds_dwordx4 v11, s[62:63] offset:2048 nt
    global_load_lds_dwordx4 v12, s[62:63] offset:3072 nt
    s_add_u32 s62, s62, 65536
    s_addc_u32 s63, s63, 0
    s_add_u32 m0, m0, 4096
    s_nop 0
    global_load_lds_dwordx4 v9, s[62:63] offset:0 nt
    global_load_lds_dwordx4 v10, s[62:63] offset:1024 nt
    global_load_lds_dwordx4 v11, s[62:63] offset:2048 nt
    global_load_lds_dwordx4 v12, s[62:63] offset:3072 nt
    s_add_u32 s62, s62, 65536
    s_addc_u32 s63, s63, 0
    s_add_u32 m0, m0, 4096
    s_nop 0
    global_load_lds_dwordx4 v9, s[62:63] offset:0 nt
    global_load_lds_dwordx4 v10, s[62:63] offset:1024 nt
    global_load_lds_dwordx4 v11, s[62:63] offset:2048 nt
    global_load_lds_dwordx4 v12, s[62:63] offset:3072 nt
    s_add_u32 s62, s62, 65536
    s_addc_u32 s63, s63, 0
    s_add_u32 m0, m0, 4096
    s_nop 0
    global_load_lds_dwordx4 v9, s[62:63] offset:0 nt
    global_load_lds_dwordx4 v10, s[62:63] offset:1024 nt
    global_load_lds_dwordx4 v11, s[62:63] offset:2048 nt
    global_load_lds_dwordx4 v12, s[62:63] offset:3072 nt
    s_add_u32 s62, s62, 65536
    s_addc_u32 s63, s63, 0
    s_add_u32 m0, m0, 4096
    s_nop 0
    global_load_lds_dwordx4 v9, s[62:63] offset:0 nt
    global_load_lds_dwordx4 v10, s[62:63] offset:1024 nt
    global_load_lds_dwordx4 v11, s[62:63] offset:2048 nt
    global_load_lds_dwordx4 v12, s[62:63] offset:3072 nt
    s_add_u32 s62, s62, 65536
    s_addc_u32 s63, s63, 0
    s_add_u32 m0, m0, 4096
    s_nop 0
    global_load_lds_dwordx4 v9, s[62:63] offset:0 nt
    global_load_lds_dwordx4 v10, s[62:63] offset:1024 nt
    global_load_lds_dwordx4 v11, s[62:63] offset:2048 nt
    global_load_lds_dwordx4 v12, s[62:63] offset:3072 nt
    s_add_u32 s62, s62, 65536
    s_addc_u32 s63, s63, 0
    s_add_u32 m0, m0, 4096
    s_nop 0
    global_load_lds_dwordx4 v9, s[62:63] offset:0 nt
    global_load_lds_dwordx4 v10, s[62:63] offset:1024 nt
    global_load_lds_dwordx4 v11, s[62:63] offset:2048 nt
    global_load_lds_dwordx4 v12, s[62:63] offset:3072 nt
    s_add_u32 s62, s62, 65536
    s_addc_u32 s63, s63, 0
    s_add_u32 m0, m0, 4096
    s_nop 0
    global_load_lds_dwordx4 v9, s[62:63] offset:0 nt
    global_load_lds_dwordx4 v10, s[62:63] offset:1024 nt
    global_load_lds_dwordx4 v11, s[62:63] offset:2048 nt
    global_load_lds_dwordx4 v12, s[62:63] offset:3072 nt
    s_add_u32 s62, s62, 65536
    s_addc_u32 s63, s63, 0
    s_add_u32 m0, m0, 4096
    s_nop 0
    global_load_lds_dwordx4 v9, s[62:63] offset:0 nt
    global_load_lds_dwordx4 v10, s[62:63] offset:1024 nt
    global_load_lds_dwordx4 v11, s[62:63] offset:2048 nt
    global_load_lds_dwordx4 v12, s[62:63] offset:3072 nt
    s_add_u32 s62, s62, 65536
    s_addc_u32 s63, s63, 0
    s_add_u32 m0, m0, 4096
    s_nop 0
    global_load_lds_dwordx4 v9, s[62:63] offset:0 nt
    global_load_lds_dwordx4 v10, s[62:63] offset:1024 nt
    global_load_lds_dwordx4 v11, s[62:63] offset:2048 nt
    global_load_lds_dwordx4 v12, s[62:63] offset:3072 nt
    s_add_u32 s62, s62, 65536
    s_addc_u32 s63, s63, 0
    s_add_u32 m0, m0, 4096
    s_nop 0
    global_load_lds_dwordx4 v9, s[62:63] offset:0 nt
    global_load_lds_dwordx4 v10, s[62:63] offset:1024 nt
    global_load_lds_dwordx4 v11, s[62:63] offset:2048 nt
    global_load_lds_dwordx4 v12, s[62:63] offset:3072 nt
    s_waitcnt vmcnt(47)
    s_add_u32 s62, s62, 65536
    s_addc_u32 s63, s63, 0
    s_add_u32 m0, m0, 4096
    s_nop 0
    global_load_lds_dwordx4 v9, s[62:63] offset:0 nt
    s_waitcnt vmcnt(47)
    global_load_lds_dwordx4 v10, s[62:63] offset:1024 nt
    s_waitcnt vmcnt(47)
    global_load_lds_dwordx4 v11, s[62:63] offset:2048 nt
    s_waitcnt vmcnt(47)
    global_load_lds_dwordx4 v12, s[62:63] offset:3072 nt
    s_waitcnt vmcnt(47)
    s_add_u32 s62, s62, 65536
    s_addc_u32 s63, s63, 0
    s_add_u32 m0, m0, 4096
    s_nop 0
    global_load_lds_dwordx4 v9, s[62:63] offset:0 nt
    s_waitcnt vmcnt(47)
    global_load_lds_dwordx4 v10, s[62:63] offset:1024 nt
    s_waitcnt vmcnt(47)
    global_load_lds_dwordx4 v11, s[62:63] offset:2048 nt
    s_waitcnt vmcnt(47)
    v_mov_b32 v6, 2
    ds_write_b32 v5, v6
    global_load_lds_dwordx4 v12, s[62:63] offset:3072 nt
    s_waitcnt vmcnt(47)
    s_add_u32 s62, s62, 65536
    s_addc_u32 s63, s63, 0
    s_add_u32 m0, m0, 4096
    s_nop 0
    global_load_lds_dwordx4 v9, s[62:63] offset:0 nt
    s_waitcnt vmcnt(47)
    global_load_lds_dwordx4 v10, s[62:63] offset:1024 nt
    s_waitcnt vmcnt(47)
    global_load_lds_dwordx4 v11, s[62:63] offset:2048 nt
    s_waitcnt vmcnt(47)
    global_load_lds_dwordx4 v12, s[62:63] offset:3072 nt
    s_waitcnt vmcnt(47)
    s_add_u32 s62, s62, 65536
    s_addc_u32 s63, s63, 0
    s_add_u32 m0, m0, 4096
    s_nop 0
    global_load_lds_dwordx4 v9, s[62:63] offset:0 nt
    s_waitcnt vmcnt(47)
    global_load_lds_dwordx4 v10, s[62:63] offset:1024 nt
    s_waitcnt vmcnt(47)
    global_load_lds_dwordx4 v11, s[62:63] offset:2048 nt
    s_waitcnt vmcnt(47)
    v_mov_b32 v6, 3
    ds_write_b32 v5, v6
    global_load_lds_dwordx4 v12, s[62:63] offset:3072 nt
    s_waitcnt vmcnt(47)
    s_mov_b32 m0, 65536
    s_nop 0
    global_load_lds_dwordx4 v13, s[60:61] offset:0 nt
    s_waitcnt vmcnt(47)
    global_load_lds_dwordx4 v14, s[60:61] offset:1024 nt
    s_waitcnt vmcnt(47)
    global_load_lds_dwordx4 v13, s[60:61] offset:2048 nt
    s_waitcnt vmcnt(47)
    global_load_lds_dwordx4 v14, s[60:61] offset:3072 nt
    s_waitcnt vmcnt(47)
    s_add_u32 s60, s60, 65536
    s_addc_u32 s61, s61, 0
    s_add_u32 m0, m0, 4096
    s_nop 0
    global_load_lds_dwordx4 v13, s[60:61] offset:0 nt
    s_waitcnt vmcnt(47)
    global_load_lds_dwordx4 v14, s[60:61] offset:1024 nt
    s_waitcnt vmcnt(47)
    global_load_lds_dwordx4 v13, s[60:61] offset:2048 nt
    s_waitcnt vmcnt(47)
    v_mov_b32 v6, 4
    ds_write_b32 v5, v6
    global_load_lds_dwordx4 v14, s[60:61] offset:3072 nt
    s_waitcnt lgkmcnt(0)
    s_add_u32 s6, s6, 1
    v_mov_b32 v6, s6
    s_mul_i32 s53, s4, 98304
    s_lshl_b32 s56, s10, 3
    s_add_u32 s53, s53, s56
    s_add_u32 s53, s53, 272384
    v_mov_b32 v7, s53
    ds_read_b32 v2, v5 offset:52
    s_waitcnt lgkmcnt(0)
    v_readfirstlane_b32 s46, v2
    s_mov_b64 exec, 1
    s_cmp_eq_u32 s46, 1
    s_cbranch_scc0 SL_128
    global_store_dword v7, v6, s[42:43]
BK_129:
    s_mov_b64 exec, -1
    s_waitcnt vmcnt(47)
    s_add_u32 s60, s60, 65536
    s_addc_u32 s61, s61, 0
    s_add_u32 m0, m0, 4096
    s_nop 0
    global_load_lds_dwordx4 v13, s[60:61] offset:0 nt
    s_waitcnt vmcnt(47)
    global_load_lds_dwordx4 v14, s[60:61] offset:1024 nt
    s_waitcnt vmcnt(47)
    global_load_lds_dwordx4 v13, s[60:61] offset:2048 nt
    s_waitcnt vmcnt(47)
    global_load_lds_dwordx4 v14, s[60:61] offset:3072 nt
    s_waitcnt vmcnt(47)
    s_add_u32 s60, s60, 65536
    s_addc_u32 s61, s61, 0
    s_add_u32 m0, m0, 4096
    s_nop 0
    global_load_lds_dwordx4 v13, s[60:61] offset:0 nt
    s_waitcnt vmcnt(47)
    global_load_lds_dwordx4 v14, s[60:61] offset:1024 nt
    s_waitcnt vmcnt(47)
    v_mov_b32 v6, 5
    ds_write_b32 v5, v6
    global_load_lds_dwordx4 v13, s[60:61] offset:2048 nt
    s_waitcnt vmcnt(47)
    global_load_lds_dwordx4 v14, s[60:61] offset:3072 nt
    s_waitcnt vmcnt(47)
    s_add_u32 s60, s60, 65536
    s_addc_u32 s61, s61, 0
    s_add_u32 m0, m0, 4096
    s_nop 0
    global_load_lds_dwordx4 v13, s[60:61] offset:0 nt
    s_waitcnt vmcnt(47)
    global_load_lds_dwordx4 v14, s[60:61] offset:1024 nt
    s_waitcnt vmcnt(47)
    global_load_lds_dwordx4 v13, s[60:61] offset:2048 nt
    s_waitcnt vmcnt(47)
    global_load_lds_dwordx4 v14, s[60:61] offset:3072 nt
    s_waitcnt vmcnt(47)
    s_add_u32 s60, s60, 65536
    s_addc_u32 s61, s61, 0
    s_add_u32 m0, m0, 4096
    s_nop 0
    global_load_lds_dwordx4 v13, s[60:61] offset:0 nt
    s_waitcnt vmcnt(47)
    global_load_lds_dwordx4 v14, s[60:61] offset:1024 nt
    s_waitcnt vmcnt(47)
    v_mov_b32 v6, 6
    ds_write_b32 v5, v6
    global_load_lds_dwordx4 v13, s[60:61] offset:2048 nt
    s_waitcnt vmcnt(47)
    global_load_lds_dwordx4 v14, s[60:61] offset:3072 nt
    s_waitcnt vmcnt(47)
    s_add_u32 s60, s60, 65536
    s_addc_u32 s61, s61, 0
    s_add_u32 m0, m0, 4096
    s_nop 0
    global_load_lds_dwordx4 v13, s[60:61] offset:0 nt
    s_waitcnt vmcnt(47)
    global_load_lds_dwordx4 v14, s[60:61] offset:1024 nt
    s_waitcnt vmcnt(47)
    global_load_lds_dwordx4 v13, s[60:61] offset:2048 nt
    s_waitcnt vmcnt(47)
    global_load_lds_dwordx4 v14, s[60:61] offset:3072 nt
    s_waitcnt vmcnt(47)
    s_add_u32 s60, s60, 65536
    s_addc_u32 s61, s61, 0
    s_add_u32 m0, m0, 4096
    s_nop 0
    global_load_lds_dwordx4 v13, s[60:61] offset:0 nt
    s_waitcnt vmcnt(47)
    global_load_lds_dwordx4 v14, s[60:61] offset:1024 nt
    s_waitcnt vmcnt(47)
    v_mov_b32 v6, 7
    ds_write_b32 v5, v6
    global_load_lds_dwordx4 v13, s[60:61] offset:2048 nt
    s_waitcnt vmcnt(47)
    global_load_lds_dwordx4 v14, s[60:61] offset:3072 nt
    s_waitcnt vmcnt(47)
    s_add_u32 s60, s60, 65536
    s_addc_u32 s61, s61, 0
    s_add_u32 m0, m0, 4096
    s_nop 0
    global_load_lds_dwordx4 v13, s[60:61] offset:0 nt
    s_waitcnt vmcnt(47)
    global_load_lds_dwordx4 v14, s[60:61] offset:1024 nt
    s_waitcnt vmcnt(47)
    global_load_lds_dwordx4 v13, s[60:61] offset:2048 nt
    s_waitcnt vmcnt(47)
    global_load_lds_dwordx4 v14, s[60:61] offset:3072 nt
    s_waitcnt vmcnt(47)
    s_add_u32 s60, s60, 65536
    s_addc_u32 s61, s61, 0
    s_add_u32 m0, m0, 4096
    s_nop 0
    global_load_lds_dwordx4 v13, s[60:61] offset:0 nt
    s_waitcnt vmcnt(47)
    global_load_lds_dwordx4 v14, s[60:61] offset:1024 nt
    s_waitcnt vmcnt(47)
    v_mov_b32 v6, 8
    ds_write_b32 v5, v6
    global_load_lds_dwordx4 v13, s[60:61] offset:2048 nt
    s_waitcnt vmcnt(47)
    global_load_lds_dwordx4 v14, s[60:61] offset:3072 nt
    s_waitcnt vmcnt(47)
    s_add_u32 s60, s60, 65536
    s_addc_u32 s61, s61, 0
    s_add_u32 m0, m0, 4096
    s_nop 0
    global_load_lds_dwordx4 v13, s[60:61] offset:0 nt
    s_waitcnt vmcnt(47)
    global_load_lds_dwordx4 v14, s[60:61] offset:1024 nt
    s_waitcnt vmcnt(47)
    global_load_lds_dwordx4 v13, s[60:61] offset:2048 nt
    s_waitcnt vmcnt(47)
    global_load_lds_dwordx4 v14, s[60:61] offset:3072 nt
    s_waitcnt vmcnt(47)
    s_add_u32 s60, s60, 65536
    s_addc_u32 s61, s61, 0
    s_add_u32 m0, m0, 4096
    s_nop 0
    global_load_lds_dwordx4 v13, s[60:61] offset:0 nt
    s_waitcnt vmcnt(47)
    global_load_lds_dwordx4 v14, s[60:61] offset:1024 nt
    s_waitcnt vmcnt(47)
    v_mov_b32 v6, 9
    ds_write_b32 v5, v6
    global_load_lds_dwordx4 v13, s[60:61] offset:2048 nt
    s_waitcnt vmcnt(47)
    global_load_lds_dwordx4 v14, s[60:61] offset:3072 nt
    s_waitcnt vmcnt(47)
    s_add_u32 s60, s60, 65536
    s_addc_u32 s61, s61, 0
    s_add_u32 m0, m0, 4096
    s_nop 0
    global_load_lds_dwordx4 v13, s[60:61] offset:0 nt
    s_waitcnt vmcnt(47)
    global_load_lds_dwordx4 v14, s[60:61] offset:1024 nt
    s_waitcnt vmcnt(47)
    global_load_lds_dwordx4 v13, s[60:61] offset:2048 nt
    s_waitcnt vmcnt(47)
    global_load_lds_dwordx4 v14, s[60:61] offset:3072 nt
    s_waitcnt vmcnt(47)
    s_add_u32 s60, s60, 65536
    s_addc_u32 s61, s61, 0
    s_add_u32 m0, m0, 4096
    s_nop 0
    global_load_lds_dwordx4 v13, s[60:61] offset:0 nt
    s_waitcnt vmcnt(47)
    global_load_lds_dwordx4 v14, s[60:61] offset:1024 nt
    s_waitcnt vmcnt(47)
    v_mov_b32 v6, 10
    ds_write_b32 v5, v6
    global_load_lds_dwordx4 v13, s[60:61] offset:2048 nt
    s_waitcnt vmcnt(47)
    global_load_lds_dwordx4 v14, s[60:61] offset:3072 nt
    s_waitcnt vmcnt(47)
    s_add_u32 s60, s60, 65536
    s_addc_u32 s61, s61, 0
    s_add_u32 m0, m0, 4096
    s_nop 0
    global_load_lds_dwordx4 v13, s[60:61] offset:0 nt
    s_waitcnt vmcnt(47)
    global_load_lds_dwordx4 v14, s[60:61] offset:1024 nt
    s_waitcnt vmcnt(47)
    global_load_lds_dwordx4 v13, s[60:61] offset:2048 nt
    s_waitcnt vmcnt(47)
    global_load_lds_dwordx4 v14, s[60:61] offset:3072 nt
    s_waitcnt vmcnt(47)
    s_add_u32 s60, s60, 65536
    s_addc_u32 s61, s61, 0
    s_add_u32 m0, m0, 4096
    s_nop 0
    global_load_lds_dwordx4 v13, s[60:61] offset:0 nt
    s_waitcnt vmcnt(47)
    global_load_lds_dwordx4 v14, s[60:61] offset:1024 nt
    s_waitcnt vmcnt(47)
    global_load_lds_dwordx4 v13, s[60:61] offset:2048 nt
    s_waitcnt vmcnt(47)
    v_mov_b32 v6, 11
    ds_write_b32 v5, v6
    global_load_lds_dwordx4 v14, s[60:61] offset:3072 nt
    s_waitcnt vmcnt(40)
    v_mov_b32 v6, 12
    ds_write_b32 v5, v6
    s_waitcnt vmcnt(32)
    v_mov_b32 v6, 13
    ds_write_b32 v5, v6
    s_waitcnt vmcnt(24)
    v_mov_b32 v6, 14
    ds_write_b32 v5, v6
    s_waitcnt vmcnt(16)
    v_mov_b32 v6, 15
    ds_write_b32 v5, v6
    s_waitcnt vmcnt(8)
    v_mov_b32 v6, 16
    ds_write_b32 v5, v6
    s_waitcnt vmcnt(0)
    v_mov_b32 v6, 17
    ds_write_b32 v5, v6
    s_and_b32 s54, s10, 7
    s_lshr_b32 s55, s10, 3
    v_lshrrev_b32 v2, 5, v0
    v_and_b32 v3, 31, v0
    v_mul_u32_u24 v1, 3584, v2
    s_mul_i32 s56, s54, 229376
    s_mul_i32 s57, s4, 448
    s_add_u32 s56, s56, s57
    v_add_u32 v1, s56, v1
    v_add_u32 v7, 0, v2
    v_lshlrev_b32 v7, 1, v7
    v_xor_b32 v7, v7, v3
    v_cmp_gt_u32 s[84:85], 28, v7
    v_lshl_add_u32 v15, v7, 4, v1
    v_add_u32 v7, 2, v2
    v_lshlrev_b32 v7, 1, v7
    v_xor_b32 v7, v7, v3
    v_cmp_gt_u32 s[86:87], 28, v7
    v_lshl_add_u32 v16, v7, 4, v1
    v_add_u32 v7, 4, v2
    v_lshlrev_b32 v7, 1, v7
    v_xor_b32 v7, v7, v3
    v_cmp_gt_u32 s[88:89], 28, v7
    v_lshl_add_u32 v17, v7, 4, v1
    v_add_u32 v7, 6, v2
    v_lshlrev_b32 v7, 1, v7
    v_xor_b32 v7, v7, v3
    v_cmp_gt_u32 s[90:91], 28, v7
    v_lshl_add_u32 v18, v7, 4, v1
    s_cmp_ge_u32 s55, 1
    s_cselect_b32 s58, s30, s28
    s_cselect_b32 s59, s31, s29
    s_mov_b32 m0, 0
    s_mov_b32 s14, 2000000
W_130:
    ds_read_b32 v2, v5 offset:16
    s_waitcnt lgkmcnt(0)
    v_readfirstlane_b32 s15, v2
    s_cmp_ge_u32 s15, 8
    s_cbranch_scc1 AG_132
    s_sleep 1
    s_sub_u32 s14, s14, 1
    s_cbranch_scc0 W_130
    s_branch L_fail
AG_132:
OK_131:
    s_mov_b64 exec, s[84:85]
    global_load_lds_dwordx4 v15, s[58:59] nt
    s_mov_b64 exec, -1
    s_add_u32 s58, s58, 7168
    s_addc_u32 s59, s59, 0
    s_add_u32 m0, m0, 1024
    s_mov_b64 exec, s[86:87]
    global_load_lds_dwordx4 v16, s[58:59] nt
    s_mov_b64 exec, -1
    s_add_u32 s58, s58, 7168
    s_addc_u32 s59, s59, 0
    s_add_u32 m0, m0, 1024
    s_mov_b64 exec, s[84:85]
    global_load_lds_dwordx4 v15, s[58:59] nt
    s_mov_b64 exec, -1
    s_add_u32 s58, s58, 7168
    s_addc_u32 s59, s59, 0
    s_add_u32 m0, m0, 1024
    s_mov_b64 exec, s[86:87]
    global_load_lds_dwordx4 v16, s[58:59] nt
    s_mov_b64 exec, -1
    s_add_u32 s58, s58, 7168
    s_addc_u32 s59, s59, 0
    s_add_u32 m0, m0, 1024
    s_mov_b64 exec, s[88:89]
    global_load_lds_dwordx4 v17, s[58:59] nt
    s_mov_b64 exec, -1
    s_add_u32 s58, s58, 7168
    s_addc_u32 s59, s59, 0
    s_add_u32 m0, m0, 1024
    s_mov_b64 exec, s[90:91]
    global_load_lds_dwordx4 v18, s[58:59] nt
    s_mov_b64 exec, -1
    s_add_u32 s58, s58, 7168
    s_addc_u32 s59, s59, 0
    s_add_u32 m0, m0, 1024
    s_mov_b64 exec, s[88:89]
    global_load_lds_dwordx4 v17, s[58:59] nt
    s_mov_b64 exec, -1
    s_add_u32 s58, s58, 7168
    s_addc_u32 s59, s59, 0
    s_add_u32 m0, m0, 1024
    s_mov_b64 exec, s[90:91]
    global_load_lds_dwordx4 v18, s[58:59] nt
    s_mov_b64 exec, -1
    s_add_u32 s58, s58, 7168
    s_addc_u32 s59, s59, 0
    s_add_u32 m0, m0, 1024
    s_mov_b64 exec, s[84:85]
    global_load_lds_dwordx4 v15, s[58:59] nt
    s_mov_b64 exec, -1
    s_add_u32 s58, s58, 7168
    s_addc_u32 s59, s59, 0
    s_add_u32 m0, m0, 1024
    s_mov_b64 exec, s[86:87]
    global_load_lds_dwordx4 v16, s[58:59] nt
    s_mov_b64 exec, -1
    s_add_u32 s58, s58, 7168
    s_addc_u32 s59, s59, 0
    s_add_u32 m0, m0, 1024
    s_mov_b64 exec, s[84:85]
    global_load_lds_dwordx4 v15, s[58:59] nt
    s_mov_b64 exec, -1
    s_add_u32 s58, s58, 7168
    s_addc_u32 s59, s59, 0
    s_add_u32 m0, m0, 1024
    s_mov_b64 exec, s[86:87]
    global_load_lds_dwordx4 v16, s[58:59] nt
    s_mov_b64 exec, -1
    s_add_u32 s58, s58, 7168
    s_addc_u32 s59, s59, 0
    s_add_u32 m0, m0, 1024
    s_mov_b64 exec, s[88:89]
    global_load_lds_dwordx4 v17, s[58:59] nt
    s_mov_b64 exec, -1
    s_add_u32 s58, s58, 7168
    s_addc_u32 s59, s59, 0
    s_add_u32 m0, m0, 1024
    s_mov_b64 exec, s[90:91]
    global_load_lds_dwordx4 v18, s[58:59] nt
    s_mov_b64 exec, -1
    s_add_u32 s58, s58, 7168
    s_addc_u32 s59, s59, 0
    s_add_u32 m0, m0, 1024
    s_mov_b64 exec, s[88:89]
    global_load_lds_dwordx4 v17, s[58:59] nt
    s_mov_b64 exec, -1
    s_add_u32 s58, s58, 7168
    s_addc_u32 s59, s59, 0
    s_add_u32 m0, m0, 1024
    s_mov_b64 exec, s[90:91]
    global_load_lds_dwordx4 v18, s[58:59] nt
    s_mov_b64 exec, -1
    s_add_u32 s58, s58, 7168
    s_addc_u32 s59, s59, 0
    s_add_u32 m0, m0, 1024
    s_mov_b64 exec, s[84:85]
    global_load_lds_dwordx4 v15, s[58:59] nt
    s_mov_b64 exec, -1
    s_add_u32 s58, s58, 7168
    s_addc_u32 s59, s59, 0
    s_add_u32 m0, m0, 1024
    s_mov_b64 exec, s[86:87]
    global_load_lds_dwordx4 v16, s[58:59] nt
    s_mov_b64 exec, -1
    s_add_u32 s58, s58, 7168
    s_addc_u32 s59, s59, 0
    s_add_u32 m0, m0, 1024
    s_mov_b64 exec, s[84:85]
    global_load_lds_dwordx4 v15, s[58:59] nt
    s_mov_b64 exec, -1
    s_add_u32 s58, s58, 7168
    s_addc_u32 s59, s59, 0
    s_add_u32 m0, m0, 1024
    s_mov_b64 exec, s[86:87]
    global_load_lds_dwordx4 v16, s[58:59] nt
    s_mov_b64 exec, -1
    s_add_u32 s58, s58, 7168
    s_addc_u32 s59, s59, 0
    s_add_u32 m0, m0, 1024
    s_mov_b64 exec, s[88:89]
    global_load_lds_dwordx4 v17, s[58:59] nt
    s_mov_b64 exec, -1
    s_add_u32 s58, s58, 7168
    s_addc_u32 s59, s59, 0
    s_add_u32 m0, m0, 1024
    s_mov_b64 exec, s[90:91]
    global_load_lds_dwordx4 v18, s[58:59] nt
    s_mov_b64 exec, -1
    s_add_u32 s58, s58, 7168
    s_addc_u32 s59, s59, 0
    s_add_u32 m0, m0, 1024
    s_mov_b64 exec, s[88:89]
    global_load_lds_dwordx4 v17, s[58:59] nt
    s_mov_b64 exec, -1
    s_add_u32 s58, s58, 7168
    s_addc_u32 s59, s59, 0
    s_add_u32 m0, m0, 1024
    s_mov_b64 exec, s[90:91]
    global_load_lds_dwordx4 v18, s[58:59] nt
    s_mov_b64 exec, -1
    s_add_u32 s58, s58, 7168
    s_addc_u32 s59, s59, 0
    s_add_u32 m0, m0, 1024
    s_mov_b64 exec, s[84:85]
    global_load_lds_dwordx4 v15, s[58:59] nt
    s_mov_b64 exec, -1
    s_add_u32 s58, s58, 7168
    s_addc_u32 s59, s59, 0
    s_add_u32 m0, m0, 1024
    s_mov_b64 exec, s[86:87]
    global_load_lds_dwordx4 v16, s[58:59] nt
    s_mov_b64 exec, -1
    s_add_u32 s58, s58, 7168
    s_addc_u32 s59, s59, 0
    s_add_u32 m0, m0, 1024
    s_mov_b64 exec, s[84:85]
    global_load_lds_dwordx4 v15, s[58:59] nt
    s_mov_b64 exec, -1
    s_add_u32 s58, s58, 7168
    s_addc_u32 s59, s59, 0
    s_add_u32 m0, m0, 1024
    s_mov_b64 exec, s[86:87]
    global_load_lds_dwordx4 v16, s[58:59] nt
    s_mov_b64 exec, -1
    s_add_u32 s58, s58, 7168
    s_addc_u32 s59, s59, 0
    s_add_u32 m0, m0, 1024
    s_mov_b64 exec, s[88:89]
    global_load_lds_dwordx4 v17, s[58:59] nt
    s_mov_b64 exec, -1
    s_add_u32 s58, s58, 7168
    s_addc_u32 s59, s59, 0
    s_add_u32 m0, m0, 1024
    s_mov_b64 exec, s[90:91]
    global_load_lds_dwordx4 v18, s[58:59] nt
    s_mov_b64 exec, -1
    s_add_u32 s58, s58, 7168
    s_addc_u32 s59, s59, 0
    s_add_u32 m0, m0, 1024
    s_mov_b64 exec, s[88:89]
    global_load_lds_dwordx4 v17, s[58:59] nt
    s_mov_b64 exec, -1
    s_add_u32 s58, s58, 7168
    s_addc_u32 s59, s59, 0
    s_add_u32 m0, m0, 1024
    s_mov_b64 exec, s[90:91]
    global_load_lds_dwordx4 v18, s[58:59] nt
    s_mov_b64 exec, -1
    s_waitcnt vmcnt(31)
    s_min_u32 s57, s10, 13
    s_mul_i32 s56, s4, 229376
    s_lshl_b32 s57, s57, 14
    s_add_u32 s56, s56, s57
    s_add_u32 s58, s32, s56
    s_addc_u32 s59, s33, 0
    s_mov_b32 m0, 32768
    v_xor_b32 v7, 0, v4
    global_load_lds_dwordx4 v7, s[58:59] offset:0 nt
    s_waitcnt vmcnt(31)
    v_xor_b32 v7, 64, v4
    global_load_lds_dwordx4 v7, s[58:59] offset:1024 nt
    s_waitcnt vmcnt(31)
    v_xor_b32 v7, 128, v4
    global_load_lds_dwordx4 v7, s[58:59] offset:2048 nt
    s_waitcnt vmcnt(31)
    v_xor_b32 v7, 192, v4
    global_load_lds_dwordx4 v7, s[58:59] offset:3072 nt
    s_waitcnt vmcnt(31)
    s_add_u32 s58, s58, 4096
    s_addc_u32 s59, s59, 0
    s_add_u32 m0, m0, 4096
    v_xor_b32 v7, 0, v4
    global_load_lds_dwordx4 v7, s[58:59] offset:0 nt
    s_waitcnt vmcnt(31)
    v_xor_b32 v7, 64, v4
    global_load_lds_dwordx4 v7, s[58:59] offset:1024 nt
    s_waitcnt vmcnt(31)
    v_xor_b32 v7, 128, v4
    global_load_lds_dwordx4 v7, s[58:59] offset:2048 nt
    s_waitcnt vmcnt(31)
    v_xor_b32 v7, 192, v4
    global_load_lds_dwordx4 v7, s[58:59] offset:3072 nt
    s_waitcnt vmcnt(31)
    s_add_u32 s58, s58, 4096
    s_addc_u32 s59, s59, 0
    s_add_u32 m0, m0, 4096
    v_xor_b32 v7, 32, v4
    global_load_lds_dwordx4 v7, s[58:59] offset:0 nt
    s_waitcnt vmcnt(31)
    v_xor_b32 v7, 96, v4
    global_load_lds_dwordx4 v7, s[58:59] offset:1024 nt
    s_waitcnt vmcnt(31)
    v_xor_b32 v7, 160, v4
    global_load_lds_dwordx4 v7, s[58:59] offset:2048 nt
    s_waitcnt vmcnt(31)
    v_xor_b32 v7, 224, v4
    global_load_lds_dwordx4 v7, s[58:59] offset:3072 nt
    s_waitcnt vmcnt(31)
    s_add_u32 s58, s58, 4096
    s_addc_u32 s59, s59, 0
    s_add_u32 m0, m0, 4096
    v_xor_b32 v7, 32, v4
    global_load_lds_dwordx4 v7, s[58:59] offset:0 nt
    s_waitcnt vmcnt(31)
    v_xor_b32 v7, 96, v4
    global_load_lds_dwordx4 v7, s[58:59] offset:1024 nt
    s_waitcnt vmcnt(31)
    v_xor_b32 v7, 160, v4
    global_load_lds_dwordx4 v7, s[58:59] offset:2048 nt
    s_waitcnt vmcnt(31)
    v_xor_b32 v7, 224, v4
    global_load_lds_dwordx4 v7, s[58:59] offset:3072 nt
    s_waitcnt vmcnt(16)
    v_mov_b32 v6, 18
    ds_write_b32 v5, v6
    s_waitcnt vmcnt(0)
    v_mov_b32 v6, 19
    ds_write_b32 v5, v6
    s_waitcnt lgkmcnt(0)
    s_endpgm
L_loaderW:
    s_and_b32 s54, s10, 7
    s_lshr_b32 s55, s10, 3
    v_lshrrev_b32 v2, 3, v0
    v_and_b32 v3, 7, v0
    v_mul_u32_u24 v1, 6144, v2
    v_lshl_add_u32 v1, v3, 4, v1
    s_lshr_b32 s56, s10, 2
    s_mul_i32 s56, s56, 786432
    s_and_b32 s57, s10, 3
    s_lshl_b32 s57, s57, 10
    s_add_u32 s56, s56, s57
    s_lshl_b32 s57, s4, 7
    s_add_u32 s56, s56, s57
    s_add_u32 s56, s56, 2048
    v_add_u32 v1, s56, v1
    s_barrier
    s_waitcnt vmcnt(0)
    v_mov_b32 v6, 1
    ds_write_b32 v5, v6
    s_mov_b32 s14, 2000000
W_133:
    ds_read_b32 v2, v5 offset:12
    s_waitcnt lgkmcnt(0)
    v_readfirstlane_b32 s15, v2
    s_cmp_ge_u32 s15, 1
    s_cbranch_scc1 AG_135
    s_sleep 1
    s_sub_u32 s14, s14, 1
    s_cbranch_scc0 W_133
    s_branch L_fail
AG_135:
OK_134:
    s_mov_b32 m0, 65536
    s_nop 0
    global_load_lds_dwordx4 v1, s[36:37] nt
    v_add_u32 v1, 49152, v1
    s_add_u32 m0, m0, 1024
    s_nop 0
    global_load_lds_dwordx4 v1, s[36:37] nt
    v_add_u32 v1, 49152, v1
    s_add_u32 m0, m0, 1024
    s_nop 0
    global_load_lds_dwordx4 v1, s[36:37] nt
    v_add_u32 v1, 49152, v1
    s_add_u32 m0, m0, 1024
    s_nop 0
    global_load_lds_dwordx4 v1, s[36:37] nt
    v_add_u32 v1, 49152, v1
    s_add_u32 m0, m0, 1024
    s_nop 0
    global_load_lds_dwordx4 v1, s[36:37] nt
    v_add_u32 v1, 49152, v1
    s_add_u32 m0, m0, 1024
    s_nop 0
    global_load_lds_dwordx4 v1, s[36:37] nt
    v_add_u32 v1, 49152, v1
    s_add_u32 m0, m0, 1024
    s_nop 0
    global_load_lds_dwordx4 v1, s[36:37] nt
    v_add_u32 v1, 49152, v1
    s_add_u32 m0, m0, 1024
    s_nop 0
    global_load_lds_dwordx4 v1, s[36:37] nt
    v_add_u32 v1, 49152, v1
    s_add_u32 m0, m0, 1024
    s_nop 0
    global_load_lds_dwordx4 v1, s[36:37] nt
    v_add_u32 v1, 49152, v1
    s_add_u32 m0, m0, 1024
    s_nop 0
    global_load_lds_dwordx4 v1, s[36:37] nt
    v_add_u32 v1, 49152, v1
    s_add_u32 m0, m0, 1024
    s_nop 0
    global_load_lds_dwordx4 v1, s[36:37] nt
    v_add_u32 v1, 49152, v1
    s_add_u32 m0, m0, 1024
    s_nop 0
    global_load_lds_dwordx4 v1, s[36:37] nt
    v_add_u32 v1, 49152, v1
    s_add_u32 m0, m0, 1024
    s_nop 0
    global_load_lds_dwordx4 v1, s[36:37] nt
    v_add_u32 v1, 49152, v1
    s_add_u32 m0, m0, 1024
    s_nop 0
    global_load_lds_dwordx4 v1, s[36:37] nt
    v_add_u32 v1, 49152, v1
    s_add_u32 m0, m0, 1024
    s_nop 0
    global_load_lds_dwordx4 v1, s[36:37] nt
    v_add_u32 v1, 49152, v1
    s_add_u32 m0, m0, 1024
    s_nop 0
    global_load_lds_dwordx4 v1, s[36:37] nt
    s_waitcnt vmcnt(0)
    v_mov_b32 v6, 2
    ds_write_b32 v5, v6
    s_mov_b32 s14, 2000000
W_136:
    ds_read_b32 v2, v5 offset:40
    s_waitcnt lgkmcnt(0)
    v_readfirstlane_b32 s15, v2
    s_cmp_ge_u32 s15, 1
    s_cbranch_scc1 AG_138
    s_sleep 1
    s_sub_u32 s14, s14, 1
    s_cbranch_scc0 W_136
    s_branch L_fail
AG_138:
OK_137:
    s_lshl_b32 s56, s4, 19
    s_lshl_b32 s57, s10, 15
    s_add_u32 s56, s56, s57
    s_add_u32 s58, s24, s56
    s_addc_u32 s59, s25, 0
    s_mov_b32 m0, 32768
    v_xor_b32 v7, 0, v4
    global_load_lds_dwordx4 v7, s[58:59] offset:0 nt
    v_xor_b32 v7, 32, v4
    global_load_lds_dwordx4 v7, s[58:59] offset:1024 nt
    v_xor_b32 v7, 64, v4
    global_load_lds_dwordx4 v7, s[58:59] offset:2048 nt
    v_xor_b32 v7, 96, v4
    global_load_lds_dwordx4 v7, s[58:59] offset:3072 nt
    s_add_u32 s58, s58, 4096
    s_addc_u32 s59, s59, 0
    s_add_u32 m0, m0, 4096
    v_xor_b32 v7, 0, v4
    global_load_lds_dwordx4 v7, s[58:59] offset:0 nt
    v_xor_b32 v7, 32, v4
    global_load_lds_dwordx4 v7, s[58:59] offset:1024 nt
    v_xor_b32 v7, 64, v4
    global_load_lds_dwordx4 v7, s[58:59] offset:2048 nt
    v_xor_b32 v7, 96, v4
    global_load_lds_dwordx4 v7, s[58:59] offset:3072 nt
    s_add_u32 s58, s58, 4096
    s_addc_u32 s59, s59, 0
    s_add_u32 m0, m0, 4096
    v_xor_b32 v7, 128, v4
    global_load_lds_dwordx4 v7, s[58:59] offset:0 nt
    v_xor_b32 v7, 160, v4
    global_load_lds_dwordx4 v7, s[58:59] offset:1024 nt
    v_xor_b32 v7, 192, v4
    global_load_lds_dwordx4 v7, s[58:59] offset:2048 nt
    v_xor_b32 v7, 224, v4
    global_load_lds_dwordx4 v7, s[58:59] offset:3072 nt
    s_add_u32 s58, s58, 4096
    s_addc_u32 s59, s59, 0
    s_add_u32 m0, m0, 4096
    v_xor_b32 v7, 128, v4
    global_load_lds_dwordx4 v7, s[58:59] offset:0 nt
    v_xor_b32 v7, 160, v4
    global_load_lds_dwordx4 v7, s[58:59] offset:1024 nt
    v_xor_b32 v7, 192, v4
    global_load_lds_dwordx4 v7, s[58:59] offset:2048 nt
    v_xor_b32 v7, 224, v4
    global_load_lds_dwordx4 v7, s[58:59] offset:3072 nt
    s_add_u32 s58, s58, 4096
    s_addc_u32 s59, s59, 0
    s_add_u32 m0, m0, 4096
    v_xor_b32 v7, 0, v4
    global_load_lds_dwordx4 v7, s[58:59] offset:0 nt
    v_xor_b32 v7, 32, v4
    global_load_lds_dwordx4 v7, s[58:59] offset:1024 nt
    v_xor_b32 v7, 64, v4
    global_load_lds_dwordx4 v7, s[58:59] offset:2048 nt
    v_xor_b32 v7, 96, v4
    global_load_lds_dwordx4 v7, s[58:59] offset:3072 nt
    s_add_u32 s58, s58, 4096
    s_addc_u32 s59, s59, 0
    s_add_u32 m0, m0, 4096
    v_xor_b32 v7, 0, v4
    global_load_lds_dwordx4 v7, s[58:59] offset:0 nt
    v_xor_b32 v7, 32, v4
    global_load_lds_dwordx4 v7, s[58:59] offset:1024 nt
    v_xor_b32 v7, 64, v4
    global_load_lds_dwordx4 v7, s[58:59] offset:2048 nt
    v_xor_b32 v7, 96, v4
    global_load_lds_dwordx4 v7, s[58:59] offset:3072 nt
    s_add_u32 s58, s58, 4096
    s_addc_u32 s59, s59, 0
    s_add_u32 m0, m0, 4096
    v_xor_b32 v7, 128, v4
    global_load_lds_dwordx4 v7, s[58:59] offset:0 nt
    v_xor_b32 v7, 160, v4
    global_load_lds_dwordx4 v7, s[58:59] offset:1024 nt
    v_xor_b32 v7, 192, v4
    global_load_lds_dwordx4 v7, s[58:59] offset:2048 nt
    v_xor_b32 v7, 224, v4
    global_load_lds_dwordx4 v7, s[58:59] offset:3072 nt
    s_add_u32 s58, s58, 4096
    s_addc_u32 s59, s59, 0
    s_add_u32 m0, m0, 4096
    v_xor_b32 v7, 128, v4
    global_load_lds_dwordx4 v7, s[58:59] offset:0 nt
    v_xor_b32 v7, 160, v4
    global_load_lds_dwordx4 v7, s[58:59] offset:1024 nt
    v_xor_b32 v7, 192, v4
    global_load_lds_dwordx4 v7, s[58:59] offset:2048 nt
    v_xor_b32 v7, 224, v4
    global_load_lds_dwordx4 v7, s[58:59] offset:3072 nt
    ds_write_b32 v5, v8 offset:20
    s_waitcnt vmcnt(0)
    v_mov_b32 v6, 3
    ds_write_b32 v5, v6
    s_waitcnt lgkmcnt(0)
    s_barrier
    s_waitcnt lgkmcnt(0)
    s_endpgm
SL_15:
    global_store_dwordx4 v35, v[112:115], s[44:45] sc1
    s_branch BK_16
SL_30:
    global_store_dwordx4 v31, v[136:139], s[44:45] sc1
    s_branch BK_31
SL_34:
    global_store_dwordx4 v25, v[136:139], s[44:45] sc1
    s_branch BK_35
SL_56:
    global_store_dwordx4 v7, v[104:107], s[44:45] sc1
    s_branch BK_57
SL_60:
    global_store_dword v45, v46, s[44:45] sc1
    global_store_dword v45, v47, s[44:45] offset:64 sc1
    s_branch BK_61
SL_72:
    global_store_dword v76, v81, s[44:45] offset:0 sc1
    s_branch BK_73
SL_83:
    global_store_dwordx4 v29, v[104:107], s[44:45] sc1
    s_branch BK_84
SL_91:
    global_store_dwordx4 v31, v[108:111], s[44:45] sc1
    s_branch BK_92
SL_103:
    global_store_dword v62, v5, s[44:45] sc1
    s_branch BK_104
SL_128:
    global_store_dword v7, v6, s[42:43] sc1
    s_branch BK_129
L_fail:
L_exit:
    s_endpgm
L_codeend:
.section .rodata,"a"
.p2align 6
.amdhsa_kernel adaLN_cond__sliding_block_cached__glu_gated_glu__decode_kernel
  .amdhsa_next_free_vgpr 144
  .amdhsa_next_free_sgpr 100
  .amdhsa_accum_offset 144
  .amdhsa_group_segment_fixed_size 0
  .amdhsa_kernarg_size 112
  .amdhsa_user_sgpr_count 2
  .amdhsa_user_sgpr_kernarg_segment_ptr 1
  .amdhsa_system_sgpr_workgroup_id_x 1
  .amdhsa_float_denorm_mode_32 3
.end_amdhsa_kernel
```
